```python
import torch

def _softmax(x, axis=-1):
    return torch.softmax(x, dim=axis)
def _gelu(x):
    return torch.nn.functional.gelu(x, approximate="tanh")
def _silu(x):
    return torch.nn.functional.silu(x)
def _sigmoid(x):
    return torch.sigmoid(x)
def _layernorm(x, axis=-1, eps=1e-5):
    m = x.mean(dim=axis, keepdim=True)
    v = x.var(dim=axis, keepdim=True, unbiased=False)
    return (x - m) / torch.sqrt(v + eps)
def _scatter_add(tgt, idx, src, axis=0):
    return tgt.clone().index_add_(axis, idx, src)
def _segment_sum(src, seg, n):
    out = torch.zeros((n,) + src.shape[1:], dtype=src.dtype)
    return out.index_add_(0, seg, src)
def _pad(x, pw):
    flat = tuple(v for pair in reversed(pw) for v in pair)
    return torch.nn.functional.pad(x, flat)

kernel_name = 'concat_heads__mha_block_cached__gqa_block_cached__near_ridge'

def setup_inputs():

    _w = (lambda a: (lambda t: t.to(torch.bfloat16) if t.is_floating_point() else t)(torch.as_tensor(a)))
    def _A_setup():
        B, Sq, D = 16, 64, 576
        H, Sk, Dh = 32, 64, 128
        return {
            "x": _w((lambda *s: torch.randn(*s, dtype=torch.bfloat16) * 0.8)(B, Sq, D)),
            "k_cache": _w((lambda *s: torch.randn(*s, dtype=torch.bfloat16) * 0.8)(B, H, Sk, Dh)),
            "v_cache": _w((lambda *s: torch.randn(*s, dtype=torch.bfloat16) * 0.05)(B, H, Sk, Dh)),
            "wq": _w((lambda *s: torch.randn(*s, dtype=torch.bfloat16) * 0.8)(D, H * Dh) * (D ** -0.5)),
            "wo": _w((lambda *s: torch.randn(*s, dtype=torch.bfloat16) * 0.05)(H * Dh, D) * ((H * Dh) ** -0.5)),
        }
    _A_in = _A_setup()

    def _B_setup():
        B, Sq, D = 16, 64, 576
        Hq, Hkv, Sk, Dh = 32, 32, 64, 128
        assert Hq % Hkv == 0, (Hq, Hkv)
        return {
            "x": _w((lambda *s: torch.randn(*s, dtype=torch.bfloat16) * 0.8)(B, Sq, D)),
            "k_cache": _w((lambda *s: torch.randn(*s, dtype=torch.bfloat16) * 0.8)(B, Hkv, Sk, Dh)),
            "v_cache": _w((lambda *s: torch.randn(*s, dtype=torch.bfloat16) * 0.05)(B, Hkv, Sk, Dh)),
            "wq": _w((lambda *s: torch.randn(*s, dtype=torch.bfloat16) * 0.8)(D, Hq * Dh) * (D ** -0.5)),
            "wo": _w((lambda *s: torch.randn(*s, dtype=torch.bfloat16) * 0.05)(Hq * Dh, D) * ((Hq * Dh) ** -0.5)),
        }
    _B_in = _B_setup()

    return {
        "A_x": _A_in["x"],
        "A_k_cache": _A_in["k_cache"],
        "A_v_cache": _A_in["v_cache"],
        "A_wq": _A_in["wq"],
        "A_wo": _A_in["wo"],
        "B_x": _B_in["x"],
        "B_k_cache": _B_in["k_cache"],
        "B_v_cache": _B_in["v_cache"],
        "B_wq": _B_in["wq"],
        "B_wo": _B_in["wo"],
    }

def reference(A_x, A_k_cache, A_v_cache, A_wq, A_wo, B_x, B_k_cache, B_v_cache, B_wq, B_wo):
    def _A_ref(x, k_cache, v_cache, wq, wo):
        B, Sq, D = x.shape
        H, Dh = 32, 128
        q = (lambda x, *d: x.permute(*d))((x @ wq).reshape(B, Sq, H, Dh), 0, 2, 1, 3)
        scores = torch.einsum("bhqd,bhkd->bhqk", q, k_cache) * (Dh ** -0.5)
        p = _softmax(scores, axis=-1)
        o = torch.einsum("bhqk,bhkd->bhqd", p, v_cache)
        return (lambda x, *d: x.permute(*d))(o, 0, 2, 1, 3).reshape(B, Sq, H * Dh) @ wo

    def _B_ref(x, k_cache, v_cache, wq, wo):
        B, Sq, D = x.shape
        Hq, Dh = 32, 128
        Hkv = k_cache.shape[1]
        rep = Hq // Hkv
        q = (lambda x, *d: x.permute(*d))((x @ wq).reshape(B, Sq, Hq, Dh), 0, 2, 1, 3)
        k = (lambda x, n, axis: torch.repeat_interleave(x, n, dim=axis))(k_cache, rep, axis=1)
        v = (lambda x, n, axis: torch.repeat_interleave(x, n, dim=axis))(v_cache, rep, axis=1)
        scores = torch.einsum("bhqd,bhkd->bhqk", q, k) * (Dh ** -0.5)
        p = _softmax(scores, axis=-1)
        o = torch.einsum("bhqk,bhkd->bhqd", p, v)
        return (lambda x, *d: x.permute(*d))(o, 0, 2, 1, 3).reshape(B, Sq, Hq * Dh) @ wo

    a = _A_ref(A_x, A_k_cache, A_v_cache, A_wq, A_wo)
    b = _B_ref(B_x, B_k_cache, B_v_cache, B_wq, B_wo)
    return torch.concatenate([a, b], axis=-1)
```

```asm
; @launch grid=(256,1,1) block=(256,1,1) lds=163840
.amdgcn_target "amdgcn-amd-amdhsa--gfx950"
.text
.globl concat_heads__mha_block_cached__gqa_block_cached__near_ridge_kernel
.p2align 8
.type concat_heads__mha_block_cached__gqa_block_cached__near_ridge_kernel,@function
concat_heads__mha_block_cached__gqa_block_cached__near_ridge_kernel:
    s_lshr_b32 s3, s2, 8
    s_cbranch_scc1 L_end
    s_load_dwordx16 s[8:23], s[0:1], 0
    s_load_dwordx8 s[24:31], s[0:1], 64
    s_load_dwordx2 s[32:33], s[0:1], 96
    v_lshrrev_b32 v1, 6, v0
    v_and_b32 v240, 63, v0
    v_readfirstlane_b32 s64, v1
    s_lshr_b32 s72, s2, 3
    s_getpc_b64 s[34:35]
    v_min_u32 v6, 2, v240
    s_lshl2_add_u32 s69, s72, s64
    v_mad_u32_u24 v6, s69, 3, v6
    v_lshlrev_b32 v6, 7, v6
    global_load_dword v8, v6, s[34:35]
    v_and_b32 v4, 7, v0
    v_lshrrev_b32 v7, 3, v0
    v_bfe_u32 v6, v0, 4, 3
    v_xor_b32 v6, v6, v4
    v_mul_u32_u24 v7, 1152, v7
    v_lshl_add_u32 v251, v6, 4, v7
    s_mul_i32 s70, s72, 36864
    s_and_b32 s71, s72, 1
    s_lshl2_add_u32 s71, s71, s64
    s_lshl_b32 s71, s71, 10
    s_mov_b32 s38, 1179648
    s_mov_b32 s39, 0x20000
    s_bitcmp0_b32 s2, 2
    s_mov_b32 m0, s71
    s_waitcnt lgkmcnt(0)
    s_cselect_b64 s[36:37], s[8:9], s[18:19]
    buffer_load_dwordx4 v251, s[36:39], s70 offen lds
    s_add_u32 m0, s71, 8192
    s_add_u32 s69, s70, 128
    buffer_load_dwordx4 v251, s[36:39], s69 offen lds
    s_add_u32 m0, s71, 32768
    s_add_u32 s69, s70, 512
    buffer_load_dwordx4 v251, s[36:39], s69 offen lds
    s_bitcmp1_b32 s2, 7
    s_cbranch_scc0 L_x1
    s_add_u32 m0, s71, 16384
    s_add_u32 s69, s70, 256
    buffer_load_dwordx4 v251, s[36:39], s69 offen lds
    s_add_u32 m0, s71, 24576
    s_add_u32 s69, s70, 384
    buffer_load_dwordx4 v251, s[36:39], s69 offen lds
    s_add_u32 m0, s71, 40960
    s_add_u32 s69, s70, 640
    buffer_load_dwordx4 v251, s[36:39], s69 offen lds
    s_add_u32 m0, s71, 49152
    s_add_u32 s69, s70, 768
    buffer_load_dwordx4 v251, s[36:39], s69 offen lds
    s_add_u32 m0, s71, 57344
    s_add_u32 s69, s70, 896
    buffer_load_dwordx4 v251, s[36:39], s69 offen lds
    s_add_u32 m0, s71, 65536
    s_add_u32 s69, s70, 1024
    buffer_load_dwordx4 v251, s[36:39], s69 offen lds
L_x1:
    s_bitcmp0_b32 s2, 2
    s_cselect_b64 s[48:49], s[14:15], s[24:25]
    s_cselect_b64 s[40:41], s[10:11], s[20:21]
    s_cselect_b64 s[44:45], s[12:13], s[22:23]
    s_cselect_b64 s[52:53], s[16:17], s[26:27]
    s_mov_b32 s50, 4718592
    s_mov_b32 s51, 0x20000
    s_bfe_u32 s65, s2, 0x10002
    s_and_b32 s69, s2, 3
    s_and_b32 s66, s72, 1
    s_lshl1_add_u32 s66, s69, s66
    s_lshr_b32 s67, s72, 1
    s_lshl2_add_u32 s68, s66, s64
    v_and_b32 v2, 15, v240
    v_lshrrev_b32 v3, 4, v240
    v_lshrrev_b32 v5, 3, v240
    s_and_b32 s93, s67, 1
    s_and_b32 s92, s67, 6
    s_lshl_b32 s92, s92, 1
    s_bitcmp1_b32 s2, 7
    s_cselect_b32 s6, 0x21043210, s92
    s_cbranch_scc1 L_sq
    s_mov_b32 s6, 0x4444
L_sq:
    s_lshr_b32 s6, s6, s92
    s_and_b32 s82, s6, 15
    s_lshl_b32 s69, s93, 18
    s_lshl_b32 s72, s68, 8
    s_add_u32 s69, s69, s72
    v_lshlrev_b32 v6, 16, v3
    v_lshl_add_u32 v6, v2, 4, v6
    v_add_u32 v241, s69, v6
    v_xor_b32 v242, 0x40000, v241
    s_lshl_b32 s83, s82, 19
    s_lshl_b32 s84, s82, 13
    v_add_u32 v243, s83, v241
    v_add_u32 v244, s83, v242
    s_mov_b32 s73, 8192
    s_mov_b32 s74, 16384
    s_mov_b32 s75, 24576
    s_mov_b32 s76, 32768
    s_mov_b32 s77, 40960
    s_mov_b32 s78, 49152
    s_mov_b32 s79, 57344
    buffer_load_dwordx4 v[128:131], v243, s[48:51], 0 offen
    buffer_load_dwordx4 v[132:135], v243, s[48:51], s73 offen
    buffer_load_dwordx4 v[136:139], v243, s[48:51], s74 offen
    buffer_load_dwordx4 v[140:143], v243, s[48:51], s75 offen
    buffer_load_dwordx4 v[144:147], v243, s[48:51], s76 offen
    buffer_load_dwordx4 v[148:151], v243, s[48:51], s77 offen
    buffer_load_dwordx4 v[152:155], v243, s[48:51], s78 offen
    buffer_load_dwordx4 v[156:159], v243, s[48:51], s79 offen
    s_mov_b32 s100, s70
    s_mov_b32 s101, s71
    s_mov_b32 s22, s70
    s_mov_b32 s23, s71
    s_bitcmp1_b32 s2, 7
    s_cbranch_scc1 L_sq1
    s_and_b32 s6, s6, 0xf
    s_or_b32 s6, s6, 0x32100
    s_lshr_b32 s94, 0x7658765, s92
    s_and_b32 s94, s94, 0xffff
    s_mov_b32 s95, 0
    s_lshl_b64 s[94:95], s[94:95], 20
    s_or_b32 s6, s6, s94
    s_mov_b32 s7, s95
    s_branch L_sq2
L_sq1:
    s_and_b32 s6, s6, 0xfffff
    s_or_b32 s6, s6, 0x0
    s_lshr_b32 s94, 0x7658765, s92
    s_and_b32 s94, s94, 0xffff
    s_mov_b32 s95, 0
    s_lshl_b64 s[94:95], s[94:95], 20
    s_or_b32 s6, s6, s94
    s_mov_b32 s7, s95
L_sq2:
    s_mov_b32 s42, 8388608
    s_mov_b32 s43, 0x20000
    s_mov_b32 s46, 8388608
    s_mov_b32 s47, 0x20000
    s_mov_b32 s54, 4718592
    s_mov_b32 s55, 0x20000
    s_mov_b32 s56, s28
    s_mov_b32 s57, s29
    s_mov_b32 s58, 2359296
    s_mov_b32 s59, 0x20000
    s_mov_b32 s60, s32
    s_mov_b32 s61, s33
    s_mov_b32 s62, 0x10000000
    s_mov_b32 s63, 0x20000
    s_mov_b32 s28, s30
    s_mov_b32 s29, s31
    s_mov_b32 s30, 256
    s_mov_b32 s31, 0x20000
    s_mov_b32 s80, 0x05040100
    s_mov_b32 s81, 0x07060302
    s_mov_b32 s86, 4096
    s_mov_b32 s87, 12288
    s_mov_b32 s90, 0x3e0293ee
    s_mul_i32 s88, s64, 17408
    s_add_u32 s88, s88, 73728
    s_lshl_b32 s89, s64, 13
    s_add_u32 s89, s89, 65536
    s_lshr_b32 s69, s67, 3
    s_and_b32 s85, s67, 1
    s_lshl1_add_u32 s85, s69, s85
    s_lshl_b32 s91, s65, 4
    s_add_u32 s91, s91, s67
    s_lshl_b32 s69, s91, 10
    s_add_u32 s69, s69, 33554432
    s_lshl_b32 s70, s66, 7
    s_add_u32 s33, s69, s70
    s_lshl_b32 s70, s64, 5
    s_add_u32 s33, s33, s70
    s_lshl_b32 s3, s91, 2
    v_lshlrev_b32 v6, 4, v240
    v_accvgpr_write_b32 a84, -1
    v_accvgpr_write_b32 a85, -1
    v_accvgpr_write_b32 a86, -1
    v_accvgpr_write_b32 a87, -1
    s_mul_i32 s34, s66, 73728
    s_add_u32 s35, s34, 57344
    s_mov_b32 s4, s69
    v_lshlrev_b32 v10, 4, v240
    s_lshl_b32 s69, s93, 2
    v_add_u32 v6, s69, v3
    v_lshrrev_b32 v7, 1, v2
    v_xor_b32 v6, v6, v7
    v_lshlrev_b32 v6, 4, v6
    v_lshrrev_b32 v7, 3, v2
    v_lshl_add_u32 v6, v7, 10, v6
    v_lshl_add_u32 v245, v4, 7, v6
    v_xor_b32 v246, 64, v245
    v_add_u32 v247, s84, v245
    v_add_u32 v248, s84, v246
    s_lshl_b32 s69, s67, 5
    s_add_u32 s69, s69, s68
    s_lshl_b32 s69, s69, 14
    v_lshlrev_b32 v6, 8, v3
    v_add_u32 v6, s69, v6
    v_lshl_add_u32 v250, v2, 4, v6
    v_xor_b32 v7, v2, v3
    v_lshl_add_u32 v249, v7, 4, v6
    v_lshrrev_b32 v6, 2, v5
    v_lshlrev_b32 v6, 4, v6
    v_bfe_u32 v7, v5, 1, 1
    v_lshl_add_u32 v6, v7, 3, v6
    v_and_b32 v7, 1, v5
    v_add_u32 v6, v6, v7
    s_lshl_b32 s69, s66, 9
    s_lshl_b32 s70, s64, 1
    s_add_u32 s69, s69, s70
    v_add_u32 v6, s69, v6
    v_mul_u32_u24 v6, 1152, v6
    v_xor_b32 v7, s70, v4
    v_lshl_add_u32 v252, v7, 4, v6
    v_bfe_u32 v6, v240, 4, 1
    v_bfe_u32 v7, v240, 3, 1
    v_lshl_add_u32 v6, v6, 1, v7
    v_xor_b32 v7, s64, v6
    v_lshlrev_b32 v7, 5, v7
    v_lshl_add_u32 v6, v6, 13, v7
    v_bfe_u32 v7, v240, 5, 1
    v_lshl_add_u32 v6, v7, 8, v6
    v_bfe_u32 v7, v240, 2, 1
    v_lshl_add_u32 v6, v7, 7, v6
    v_and_b32 v7, 3, v240
    v_lshl_add_u32 v6, v7, 3, v6
    v_add_u32 v253, 65536, v6
    s_mul_i32 s69, s91, 589824
    s_lshl_b32 s70, s64, 11
    s_add_u32 s69, s69, s70
    v_lshlrev_b32 v6, 4, v240
    v_add_u32 v255, s69, v6
    s_lshr_b32 s70, s2, 3
    s_xor_b32 s70, s70, 1
    s_mul_i32 s70, s70, 36864
    s_xor_b32 s71, s101, 4096
    s_mov_b32 s24, s70
    s_mov_b32 s25, s71
    s_add_u32 m0, s71, 0
    s_nop 0
    buffer_load_dwordx4 v251, s[36:39], s70 offen lds
    s_add_u32 m0, s71, 8192
    s_add_u32 s69, s70, 128
    buffer_load_dwordx4 v251, s[36:39], s69 offen lds
    s_add_u32 m0, s71, 32768
    s_add_u32 s69, s70, 512
    buffer_load_dwordx4 v251, s[36:39], s69 offen lds
    s_bitcmp1_b32 s2, 7
    s_cbranch_scc0 L_x0
    s_add_u32 m0, s71, 16384
    s_add_u32 s69, s70, 256
    buffer_load_dwordx4 v251, s[36:39], s69 offen lds
    s_add_u32 m0, s71, 24576
    s_add_u32 s69, s70, 384
    buffer_load_dwordx4 v251, s[36:39], s69 offen lds
    s_add_u32 m0, s71, 40960
    s_add_u32 s69, s70, 640
    buffer_load_dwordx4 v251, s[36:39], s69 offen lds
    s_add_u32 m0, s71, 49152
    s_add_u32 s69, s70, 768
    buffer_load_dwordx4 v251, s[36:39], s69 offen lds
    s_add_u32 m0, s71, 57344
    s_add_u32 s69, s70, 896
    buffer_load_dwordx4 v251, s[36:39], s69 offen lds
    s_add_u32 m0, s71, 65536
    s_add_u32 s69, s70, 1024
    buffer_load_dwordx4 v251, s[36:39], s69 offen lds
L_x0:
    buffer_load_dwordx4 v[160:163], v244, s[48:51], 0 offen
    buffer_load_dwordx4 v[164:167], v244, s[48:51], s73 offen
    buffer_load_dwordx4 v[168:171], v244, s[48:51], s74 offen
    buffer_load_dwordx4 v[172:175], v244, s[48:51], s75 offen
    buffer_load_dwordx4 v[176:179], v244, s[48:51], s76 offen
    buffer_load_dwordx4 v[180:183], v244, s[48:51], s77 offen
    buffer_load_dwordx4 v[184:187], v244, s[48:51], s78 offen
    buffer_load_dwordx4 v[188:191], v244, s[48:51], s79 offen
    s_cmp_eq_u32 s68, 0
    s_cbranch_scc0 L_nolead
    buffer_load_dwordx4 a[88:91], v10, s[60:63], s4 offen sc1
L_nolead:
    v_lshrrev_b32 v6, 2, v2
    v_lshlrev_b32 v6, 10, v6
    v_bfe_u32 v7, v240, 3, 1
    v_lshl_add_u32 v6, v7, 7, v6
    v_and_b32 v7, 3, v240
    v_mul_u32_u24 v7, 272, v7
    v_lshl_add_u32 v7, v3, 6, v7
    v_add3_u32 v254, v6, v7, s88
    s_waitcnt vmcnt(8)
    s_barrier
    ds_read_b128 a[0:3], v247 offset:0
    ds_read_b128 a[4:7], v247 offset:2048
    ds_read_b128 a[8:11], v247 offset:4096
    ds_read_b128 a[12:15], v247 offset:6144
    v_perm_b32 v224, v132, v128, s80
    v_perm_b32 v225, v140, v136, s80
    v_perm_b32 v226, v148, v144, s80
    v_perm_b32 v227, v156, v152, s80
    v_perm_b32 v228, v132, v128, s81
    v_perm_b32 v229, v140, v136, s81
    v_perm_b32 v230, v148, v144, s81
    v_perm_b32 v231, v156, v152, s81
    s_waitcnt lgkmcnt(0)
    v_mfma_f32_16x16x32_bf16 v[0:3], v[224:227], a[0:3], 0
    s_lshr_b64 s[6:7], s[6:7], 4
    s_and_b32 s82, s6, 15
    s_lshl_b32 s83, s82, 19
    v_perm_b32 v232, v133, v129, s80
    v_add_u32 v243, s83, v241
    v_mfma_f32_16x16x32_bf16 v[32:35], v[224:227], a[4:7], 0
    buffer_load_dwordx4 v[192:195], v243, s[48:51], 0 offen
    v_perm_b32 v233, v141, v137, s80
    v_mfma_f32_16x16x32_bf16 v[64:67], v[224:227], a[8:11], 0
    v_perm_b32 v234, v149, v145, s80
    v_mfma_f32_16x16x32_bf16 v[96:99], v[224:227], a[12:15], 0
    ds_read_b128 a[16:19], v248 offset:0
    v_perm_b32 v235, v157, v153, s80
    v_mfma_f32_16x16x32_bf16 v[4:7], v[228:231], a[0:3], 0
    v_perm_b32 v236, v133, v129, s81
    v_add_u32 v244, s83, v242
    v_mfma_f32_16x16x32_bf16 v[36:39], v[228:231], a[4:7], 0
    buffer_load_dwordx4 v[196:199], v243, s[48:51], s73 offen
    v_perm_b32 v237, v141, v137, s81
    v_mfma_f32_16x16x32_bf16 v[68:71], v[228:231], a[8:11], 0
    s_lshl_b32 s84, s82, 13
    v_perm_b32 v238, v149, v145, s81
    v_mfma_f32_16x16x32_bf16 v[100:103], v[228:231], a[12:15], 0
    ds_read_b128 a[20:23], v248 offset:2048
    v_perm_b32 v239, v157, v153, s81
    v_mfma_f32_16x16x32_bf16 v[8:11], v[232:235], a[0:3], 0
    v_perm_b32 v224, v134, v130, s80
    v_add_u32 v247, s84, v245
    v_mfma_f32_16x16x32_bf16 v[40:43], v[232:235], a[4:7], 0
    buffer_load_dwordx4 v[200:203], v243, s[48:51], s74 offen
    v_perm_b32 v225, v142, v138, s80
    v_mfma_f32_16x16x32_bf16 v[72:75], v[232:235], a[8:11], 0
    v_perm_b32 v226, v150, v146, s80
    v_mfma_f32_16x16x32_bf16 v[104:107], v[232:235], a[12:15], 0
    ds_read_b128 a[24:27], v248 offset:4096
    v_perm_b32 v227, v158, v154, s80
    v_mfma_f32_16x16x32_bf16 v[12:15], v[236:239], a[0:3], 0
    v_perm_b32 v228, v134, v130, s81
    v_mfma_f32_16x16x32_bf16 v[44:47], v[236:239], a[4:7], 0
    buffer_load_dwordx4 v[204:207], v243, s[48:51], s75 offen
    v_perm_b32 v229, v142, v138, s81
    v_mfma_f32_16x16x32_bf16 v[76:79], v[236:239], a[8:11], 0
    v_perm_b32 v230, v150, v146, s81
    v_mfma_f32_16x16x32_bf16 v[108:111], v[236:239], a[12:15], 0
    ds_read_b128 a[28:31], v248 offset:6144
    v_perm_b32 v231, v158, v154, s81
    v_mfma_f32_16x16x32_bf16 v[16:19], v[224:227], a[0:3], 0
    v_perm_b32 v232, v135, v131, s80
    v_mfma_f32_16x16x32_bf16 v[48:51], v[224:227], a[4:7], 0
    buffer_load_dwordx4 v[208:211], v243, s[48:51], s76 offen
    v_perm_b32 v233, v143, v139, s80
    v_mfma_f32_16x16x32_bf16 v[80:83], v[224:227], a[8:11], 0
    v_perm_b32 v234, v151, v147, s80
    v_mfma_f32_16x16x32_bf16 v[112:115], v[224:227], a[12:15], 0
    v_perm_b32 v235, v159, v155, s80
    v_mfma_f32_16x16x32_bf16 v[20:23], v[228:231], a[0:3], 0
    v_perm_b32 v236, v135, v131, s81
    v_mfma_f32_16x16x32_bf16 v[52:55], v[228:231], a[4:7], 0
    buffer_load_dwordx4 v[212:215], v243, s[48:51], s77 offen
    v_perm_b32 v237, v143, v139, s81
    v_mfma_f32_16x16x32_bf16 v[84:87], v[228:231], a[8:11], 0
    v_perm_b32 v238, v151, v147, s81
    v_mfma_f32_16x16x32_bf16 v[116:119], v[228:231], a[12:15], 0
    v_perm_b32 v239, v159, v155, s81
    v_mfma_f32_16x16x32_bf16 v[24:27], v[232:235], a[0:3], 0
    s_waitcnt vmcnt(6)
    v_perm_b32 v224, v164, v160, s80
    v_mfma_f32_16x16x32_bf16 v[56:59], v[232:235], a[4:7], 0
    buffer_load_dwordx4 v[216:219], v243, s[48:51], s78 offen
    v_perm_b32 v225, v172, v168, s80
    v_mfma_f32_16x16x32_bf16 v[88:91], v[232:235], a[8:11], 0
    v_perm_b32 v226, v180, v176, s80
    v_mfma_f32_16x16x32_bf16 v[120:123], v[232:235], a[12:15], 0
    v_perm_b32 v227, v188, v184, s80
    v_mfma_f32_16x16x32_bf16 v[28:31], v[236:239], a[0:3], 0
    v_perm_b32 v228, v164, v160, s81
    v_mfma_f32_16x16x32_bf16 v[60:63], v[236:239], a[4:7], 0
    buffer_load_dwordx4 v[220:223], v243, s[48:51], s79 offen
    v_perm_b32 v229, v172, v168, s81
    v_mfma_f32_16x16x32_bf16 v[92:95], v[236:239], a[8:11], 0
    v_perm_b32 v230, v180, v176, s81
    v_mfma_f32_16x16x32_bf16 v[124:127], v[236:239], a[12:15], 0
    v_perm_b32 v231, v188, v184, s81
    s_cmp_eq_u32 s85, 0
    s_cbranch_scc0 L_b0
    s_barrier
    s_cmp_eq_u32 s68, 0
    s_cbranch_scc0 L_b0_n
    s_waitcnt vmcnt(8)
    v_accvgpr_read_b32 v232, a88
    v_accvgpr_read_b32 v233, a89
    v_accvgpr_read_b32 v234, a90
    v_accvgpr_read_b32 v235, a91
    v_readfirstlane_b32 s70, v232
L_b0_l:
    s_nop 0
    s_add_u32 s70, s70, 1
    s_cbranch_scc1 L_b0_l
    v_cmp_eq_u32 vcc, s70, v232
    v_cmp_eq_u32 s[94:95], s70, v233
    v_cmp_eq_u32 s[96:97], s70, v234
    s_or_b64 s[94:95], s[94:95], vcc
    v_cmp_eq_u32 vcc, s70, v235
    s_or_b64 s[94:95], s[94:95], s[96:97]
    s_or_b64 s[94:95], s[94:95], vcc
    s_cbranch_scc1 L_b0_l
    v_mov_b32 v236, s70
    s_mov_b64 exec, 1
    buffer_store_dword v236, off, s[28:31], s3 sc1
    s_mov_b64 exec, -1
L_b0_n:
    s_add_u32 m0, s23, 16384
    s_add_u32 s69, s22, 256
    buffer_load_dwordx4 v251, s[36:39], s69 offen lds
    s_add_u32 m0, s23, 24576
    s_add_u32 s69, s22, 384
    buffer_load_dwordx4 v251, s[36:39], s69 offen lds
    s_add_u32 m0, s23, 40960
    s_add_u32 s69, s22, 640
    buffer_load_dwordx4 v251, s[36:39], s69 offen lds
    s_add_u32 m0, s23, 49152
    s_add_u32 s69, s22, 768
    buffer_load_dwordx4 v251, s[36:39], s69 offen lds
    s_add_u32 m0, s23, 57344
    s_add_u32 s69, s22, 896
    buffer_load_dwordx4 v251, s[36:39], s69 offen lds
    s_add_u32 m0, s23, 65536
    s_add_u32 s69, s22, 1024
    buffer_load_dwordx4 v251, s[36:39], s69 offen lds
    s_add_u32 m0, s88, 0
    s_nop 0
    buffer_load_dwordx4 v249, s[40:43], 0 offen offset:0 nt lds
    buffer_load_dwordx4 v249, s[40:43], 0 offen offset:1024 nt lds
    s_add_u32 m0, s88, 128
    s_nop 0
    buffer_load_dwordx4 v249, s[40:43], 0 offen offset:2048 nt lds
    buffer_load_dwordx4 v249, s[40:43], 0 offen offset:3072 nt lds
    s_add_u32 m0, s88, 4352
    s_nop 0
    buffer_load_dwordx4 v249, s[40:43], s86 offen offset:0 nt lds
    buffer_load_dwordx4 v249, s[40:43], s86 offen offset:1024 nt lds
    s_add_u32 m0, s88, 4480
    s_nop 0
    buffer_load_dwordx4 v249, s[40:43], s86 offen offset:2048 nt lds
    buffer_load_dwordx4 v249, s[40:43], s86 offen offset:3072 nt lds
L_b0:
    s_cmp_eq_u32 s85, 0
    s_cbranch_scc0 L_b1
    s_barrier
    s_add_u32 m0, s88, 8704
    s_nop 0
    buffer_load_dwordx4 v249, s[40:43], s73 offen offset:0 nt lds
    buffer_load_dwordx4 v249, s[40:43], s73 offen offset:1024 nt lds
    s_add_u32 m0, s88, 8832
    s_nop 0
    buffer_load_dwordx4 v249, s[40:43], s73 offen offset:2048 nt lds
    buffer_load_dwordx4 v249, s[40:43], s73 offen offset:3072 nt lds
    s_add_u32 m0, s88, 13056
    s_nop 0
    buffer_load_dwordx4 v249, s[40:43], s87 offen offset:0 nt lds
    buffer_load_dwordx4 v249, s[40:43], s87 offen offset:1024 nt lds
    s_add_u32 m0, s88, 13184
    s_nop 0
    buffer_load_dwordx4 v249, s[40:43], s87 offen offset:2048 nt lds
    buffer_load_dwordx4 v249, s[40:43], s87 offen offset:3072 nt lds
L_b1:
    s_cmp_eq_u32 s85, 0
    s_cbranch_scc0 L_b2
    s_barrier
    buffer_load_dwordx4 a[32:35], v250, s[44:47], 0 offen offset:0 nt
    buffer_load_dwordx4 a[36:39], v250, s[44:47], 0 offen offset:1024 nt
    buffer_load_dwordx4 a[40:43], v250, s[44:47], 0 offen offset:2048 nt
    buffer_load_dwordx4 a[44:47], v250, s[44:47], 0 offen offset:3072 nt
    buffer_load_dwordx4 a[48:51], v250, s[44:47], s86 offen offset:0 nt
    buffer_load_dwordx4 a[52:55], v250, s[44:47], s86 offen offset:1024 nt
    buffer_load_dwordx4 a[56:59], v250, s[44:47], s86 offen offset:2048 nt
    buffer_load_dwordx4 a[60:63], v250, s[44:47], s86 offen offset:3072 nt
    s_add_u32 m0, s25, 16384
    s_add_u32 s69, s24, 256
    buffer_load_dwordx4 v251, s[36:39], s69 offen lds
    s_add_u32 m0, s25, 24576
    s_add_u32 s69, s24, 384
    buffer_load_dwordx4 v251, s[36:39], s69 offen lds
    s_add_u32 m0, s25, 40960
    s_add_u32 s69, s24, 640
    buffer_load_dwordx4 v251, s[36:39], s69 offen lds
    s_add_u32 m0, s25, 49152
    s_add_u32 s69, s24, 768
    buffer_load_dwordx4 v251, s[36:39], s69 offen lds
    s_add_u32 m0, s25, 57344
    s_add_u32 s69, s24, 896
    buffer_load_dwordx4 v251, s[36:39], s69 offen lds
    s_add_u32 m0, s25, 65536
    s_add_u32 s69, s24, 1024
    buffer_load_dwordx4 v251, s[36:39], s69 offen lds
L_b2:
    s_waitcnt lgkmcnt(0)
    v_mfma_f32_16x16x32_bf16 v[0:3], v[224:227], a[16:19], v[0:3]
    v_perm_b32 v232, v165, v161, s80
    v_add_u32 v248, s84, v246
    v_mfma_f32_16x16x32_bf16 v[32:35], v[224:227], a[20:23], v[32:35]
    buffer_load_dwordx4 v[128:131], v244, s[48:51], 0 offen
    v_perm_b32 v233, v173, v169, s80
    v_mfma_f32_16x16x32_bf16 v[64:67], v[224:227], a[24:27], v[64:67]
    v_perm_b32 v234, v181, v177, s80
    v_mfma_f32_16x16x32_bf16 v[96:99], v[224:227], a[28:31], v[96:99]
    ds_read_b128 a[0:3], v247 offset:0
    v_perm_b32 v235, v189, v185, s80
    v_mfma_f32_16x16x32_bf16 v[4:7], v[228:231], a[16:19], v[4:7]
    v_perm_b32 v236, v165, v161, s81
    v_mfma_f32_16x16x32_bf16 v[36:39], v[228:231], a[20:23], v[36:39]
    buffer_load_dwordx4 v[132:135], v244, s[48:51], s73 offen
    v_perm_b32 v237, v173, v169, s81
    v_mfma_f32_16x16x32_bf16 v[68:71], v[228:231], a[24:27], v[68:71]
    v_perm_b32 v238, v181, v177, s81
    v_mfma_f32_16x16x32_bf16 v[100:103], v[228:231], a[28:31], v[100:103]
    ds_read_b128 a[4:7], v247 offset:2048
    v_perm_b32 v239, v189, v185, s81
    v_mfma_f32_16x16x32_bf16 v[8:11], v[232:235], a[16:19], v[8:11]
    v_perm_b32 v224, v166, v162, s80
    v_mfma_f32_16x16x32_bf16 v[40:43], v[232:235], a[20:23], v[40:43]
    buffer_load_dwordx4 v[136:139], v244, s[48:51], s74 offen
    v_perm_b32 v225, v174, v170, s80
    v_mfma_f32_16x16x32_bf16 v[72:75], v[232:235], a[24:27], v[72:75]
    v_perm_b32 v226, v182, v178, s80
    v_mfma_f32_16x16x32_bf16 v[104:107], v[232:235], a[28:31], v[104:107]
    ds_read_b128 a[8:11], v247 offset:4096
    v_perm_b32 v227, v190, v186, s80
    v_mfma_f32_16x16x32_bf16 v[12:15], v[236:239], a[16:19], v[12:15]
    v_perm_b32 v228, v166, v162, s81
    v_mfma_f32_16x16x32_bf16 v[44:47], v[236:239], a[20:23], v[44:47]
    buffer_load_dwordx4 v[140:143], v244, s[48:51], s75 offen
    v_perm_b32 v229, v174, v170, s81
    v_mfma_f32_16x16x32_bf16 v[76:79], v[236:239], a[24:27], v[76:79]
    v_perm_b32 v230, v182, v178, s81
    v_mfma_f32_16x16x32_bf16 v[108:111], v[236:239], a[28:31], v[108:111]
    ds_read_b128 a[12:15], v247 offset:6144
    v_perm_b32 v231, v190, v186, s81
    v_mfma_f32_16x16x32_bf16 v[16:19], v[224:227], a[16:19], v[16:19]
    v_perm_b32 v232, v167, v163, s80
    v_mfma_f32_16x16x32_bf16 v[48:51], v[224:227], a[20:23], v[48:51]
    buffer_load_dwordx4 v[144:147], v244, s[48:51], s76 offen
    v_perm_b32 v233, v175, v171, s80
    v_mfma_f32_16x16x32_bf16 v[80:83], v[224:227], a[24:27], v[80:83]
    v_perm_b32 v234, v183, v179, s80
    v_mfma_f32_16x16x32_bf16 v[112:115], v[224:227], a[28:31], v[112:115]
    v_perm_b32 v235, v191, v187, s80
    v_mfma_f32_16x16x32_bf16 v[20:23], v[228:231], a[16:19], v[20:23]
    v_perm_b32 v236, v167, v163, s81
    v_mfma_f32_16x16x32_bf16 v[52:55], v[228:231], a[20:23], v[52:55]
    buffer_load_dwordx4 v[148:151], v244, s[48:51], s77 offen
    v_perm_b32 v237, v175, v171, s81
    v_mfma_f32_16x16x32_bf16 v[84:87], v[228:231], a[24:27], v[84:87]
    v_perm_b32 v238, v183, v179, s81
    v_mfma_f32_16x16x32_bf16 v[116:119], v[228:231], a[28:31], v[116:119]
    v_perm_b32 v239, v191, v187, s81
    v_mfma_f32_16x16x32_bf16 v[24:27], v[232:235], a[16:19], v[24:27]
    s_waitcnt vmcnt(6)
    v_perm_b32 v224, v196, v192, s80
    v_mfma_f32_16x16x32_bf16 v[56:59], v[232:235], a[20:23], v[56:59]
    buffer_load_dwordx4 v[152:155], v244, s[48:51], s78 offen
    v_perm_b32 v225, v204, v200, s80
    v_mfma_f32_16x16x32_bf16 v[88:91], v[232:235], a[24:27], v[88:91]
    v_perm_b32 v226, v212, v208, s80
    v_mfma_f32_16x16x32_bf16 v[120:123], v[232:235], a[28:31], v[120:123]
    v_perm_b32 v227, v220, v216, s80
    v_mfma_f32_16x16x32_bf16 v[28:31], v[236:239], a[16:19], v[28:31]
    v_perm_b32 v228, v196, v192, s81
    v_mfma_f32_16x16x32_bf16 v[60:63], v[236:239], a[20:23], v[60:63]
    buffer_load_dwordx4 v[156:159], v244, s[48:51], s79 offen
    v_perm_b32 v229, v204, v200, s81
    v_mfma_f32_16x16x32_bf16 v[92:95], v[236:239], a[24:27], v[92:95]
    v_perm_b32 v230, v212, v208, s81
    v_mfma_f32_16x16x32_bf16 v[124:127], v[236:239], a[28:31], v[124:127]
    v_perm_b32 v231, v220, v216, s81
    s_waitcnt lgkmcnt(0)
    v_mfma_f32_16x16x32_bf16 v[0:3], v[224:227], a[0:3], v[0:3]
    s_lshr_b64 s[6:7], s[6:7], 4
    s_and_b32 s82, s6, 15
    s_lshl_b32 s83, s82, 19
    v_perm_b32 v232, v197, v193, s80
    v_add_u32 v243, s83, v241
    v_mfma_f32_16x16x32_bf16 v[32:35], v[224:227], a[4:7], v[32:35]
    buffer_load_dwordx4 v[160:163], v243, s[48:51], 0 offen
    v_perm_b32 v233, v205, v201, s80
    v_mfma_f32_16x16x32_bf16 v[64:67], v[224:227], a[8:11], v[64:67]
    v_perm_b32 v234, v213, v209, s80
    v_mfma_f32_16x16x32_bf16 v[96:99], v[224:227], a[12:15], v[96:99]
    ds_read_b128 a[16:19], v248 offset:0
    v_perm_b32 v235, v221, v217, s80
    v_mfma_f32_16x16x32_bf16 v[4:7], v[228:231], a[0:3], v[4:7]
    v_perm_b32 v236, v197, v193, s81
    v_add_u32 v244, s83, v242
    v_mfma_f32_16x16x32_bf16 v[36:39], v[228:231], a[4:7], v[36:39]
    buffer_load_dwordx4 v[164:167], v243, s[48:51], s73 offen
    v_perm_b32 v237, v205, v201, s81
    v_mfma_f32_16x16x32_bf16 v[68:71], v[228:231], a[8:11], v[68:71]
    s_lshl_b32 s84, s82, 13
    v_perm_b32 v238, v213, v209, s81
    v_mfma_f32_16x16x32_bf16 v[100:103], v[228:231], a[12:15], v[100:103]
    ds_read_b128 a[20:23], v248 offset:2048
    v_perm_b32 v239, v221, v217, s81
    v_mfma_f32_16x16x32_bf16 v[8:11], v[232:235], a[0:3], v[8:11]
    v_perm_b32 v224, v198, v194, s80
    v_add_u32 v247, s84, v245
    v_mfma_f32_16x16x32_bf16 v[40:43], v[232:235], a[4:7], v[40:43]
    buffer_load_dwordx4 v[168:171], v243, s[48:51], s74 offen
    v_perm_b32 v225, v206, v202, s80
    v_mfma_f32_16x16x32_bf16 v[72:75], v[232:235], a[8:11], v[72:75]
    v_perm_b32 v226, v214, v210, s80
    v_mfma_f32_16x16x32_bf16 v[104:107], v[232:235], a[12:15], v[104:107]
    ds_read_b128 a[24:27], v248 offset:4096
    v_perm_b32 v227, v222, v218, s80
    v_mfma_f32_16x16x32_bf16 v[12:15], v[236:239], a[0:3], v[12:15]
    v_perm_b32 v228, v198, v194, s81
    v_mfma_f32_16x16x32_bf16 v[44:47], v[236:239], a[4:7], v[44:47]
    buffer_load_dwordx4 v[172:175], v243, s[48:51], s75 offen
    v_perm_b32 v229, v206, v202, s81
    v_mfma_f32_16x16x32_bf16 v[76:79], v[236:239], a[8:11], v[76:79]
    v_perm_b32 v230, v214, v210, s81
    v_mfma_f32_16x16x32_bf16 v[108:111], v[236:239], a[12:15], v[108:111]
    ds_read_b128 a[28:31], v248 offset:6144
    v_perm_b32 v231, v222, v218, s81
    v_mfma_f32_16x16x32_bf16 v[16:19], v[224:227], a[0:3], v[16:19]
    v_perm_b32 v232, v199, v195, s80
    v_mfma_f32_16x16x32_bf16 v[48:51], v[224:227], a[4:7], v[48:51]
    buffer_load_dwordx4 v[176:179], v243, s[48:51], s76 offen
    v_perm_b32 v233, v207, v203, s80
    v_mfma_f32_16x16x32_bf16 v[80:83], v[224:227], a[8:11], v[80:83]
    v_perm_b32 v234, v215, v211, s80
    v_mfma_f32_16x16x32_bf16 v[112:115], v[224:227], a[12:15], v[112:115]
    v_perm_b32 v235, v223, v219, s80
    v_mfma_f32_16x16x32_bf16 v[20:23], v[228:231], a[0:3], v[20:23]
    v_perm_b32 v236, v199, v195, s81
    v_mfma_f32_16x16x32_bf16 v[52:55], v[228:231], a[4:7], v[52:55]
    buffer_load_dwordx4 v[180:183], v243, s[48:51], s77 offen
    v_perm_b32 v237, v207, v203, s81
    v_mfma_f32_16x16x32_bf16 v[84:87], v[228:231], a[8:11], v[84:87]
    v_perm_b32 v238, v215, v211, s81
    v_mfma_f32_16x16x32_bf16 v[116:119], v[228:231], a[12:15], v[116:119]
    v_perm_b32 v239, v223, v219, s81
    v_mfma_f32_16x16x32_bf16 v[24:27], v[232:235], a[0:3], v[24:27]
    s_waitcnt vmcnt(6)
    v_perm_b32 v224, v132, v128, s80
    v_mfma_f32_16x16x32_bf16 v[56:59], v[232:235], a[4:7], v[56:59]
    buffer_load_dwordx4 v[184:187], v243, s[48:51], s78 offen
    v_perm_b32 v225, v140, v136, s80
    v_mfma_f32_16x16x32_bf16 v[88:91], v[232:235], a[8:11], v[88:91]
    v_perm_b32 v226, v148, v144, s80
    v_mfma_f32_16x16x32_bf16 v[120:123], v[232:235], a[12:15], v[120:123]
    v_perm_b32 v227, v156, v152, s80
    v_mfma_f32_16x16x32_bf16 v[28:31], v[236:239], a[0:3], v[28:31]
    v_perm_b32 v228, v132, v128, s81
    v_mfma_f32_16x16x32_bf16 v[60:63], v[236:239], a[4:7], v[60:63]
    buffer_load_dwordx4 v[188:191], v243, s[48:51], s79 offen
    v_perm_b32 v229, v140, v136, s81
    v_mfma_f32_16x16x32_bf16 v[92:95], v[236:239], a[8:11], v[92:95]
    v_perm_b32 v230, v148, v144, s81
    v_mfma_f32_16x16x32_bf16 v[124:127], v[236:239], a[12:15], v[124:127]
    v_perm_b32 v231, v156, v152, s81
    s_waitcnt lgkmcnt(0)
    v_mfma_f32_16x16x32_bf16 v[0:3], v[224:227], a[16:19], v[0:3]
    v_perm_b32 v232, v133, v129, s80
    v_add_u32 v248, s84, v246
    v_mfma_f32_16x16x32_bf16 v[32:35], v[224:227], a[20:23], v[32:35]
    buffer_load_dwordx4 v[192:195], v244, s[48:51], 0 offen
    v_perm_b32 v233, v141, v137, s80
    v_mfma_f32_16x16x32_bf16 v[64:67], v[224:227], a[24:27], v[64:67]
    v_perm_b32 v234, v149, v145, s80
    v_mfma_f32_16x16x32_bf16 v[96:99], v[224:227], a[28:31], v[96:99]
    ds_read_b128 a[0:3], v247 offset:0
    v_perm_b32 v235, v157, v153, s80
    v_mfma_f32_16x16x32_bf16 v[4:7], v[228:231], a[16:19], v[4:7]
    v_perm_b32 v236, v133, v129, s81
    v_mfma_f32_16x16x32_bf16 v[36:39], v[228:231], a[20:23], v[36:39]
    buffer_load_dwordx4 v[196:199], v244, s[48:51], s73 offen
    v_perm_b32 v237, v141, v137, s81
    v_mfma_f32_16x16x32_bf16 v[68:71], v[228:231], a[24:27], v[68:71]
    v_perm_b32 v238, v149, v145, s81
    v_mfma_f32_16x16x32_bf16 v[100:103], v[228:231], a[28:31], v[100:103]
    ds_read_b128 a[4:7], v247 offset:2048
    v_perm_b32 v239, v157, v153, s81
    v_mfma_f32_16x16x32_bf16 v[8:11], v[232:235], a[16:19], v[8:11]
    v_perm_b32 v224, v134, v130, s80
    v_mfma_f32_16x16x32_bf16 v[40:43], v[232:235], a[20:23], v[40:43]
    buffer_load_dwordx4 v[200:203], v244, s[48:51], s74 offen
    v_perm_b32 v225, v142, v138, s80
    v_mfma_f32_16x16x32_bf16 v[72:75], v[232:235], a[24:27], v[72:75]
    v_perm_b32 v226, v150, v146, s80
    v_mfma_f32_16x16x32_bf16 v[104:107], v[232:235], a[28:31], v[104:107]
    ds_read_b128 a[8:11], v247 offset:4096
    v_perm_b32 v227, v158, v154, s80
    v_mfma_f32_16x16x32_bf16 v[12:15], v[236:239], a[16:19], v[12:15]
    v_perm_b32 v228, v134, v130, s81
    v_mfma_f32_16x16x32_bf16 v[44:47], v[236:239], a[20:23], v[44:47]
    buffer_load_dwordx4 v[204:207], v244, s[48:51], s75 offen
    v_perm_b32 v229, v142, v138, s81
    v_mfma_f32_16x16x32_bf16 v[76:79], v[236:239], a[24:27], v[76:79]
    v_perm_b32 v230, v150, v146, s81
    v_mfma_f32_16x16x32_bf16 v[108:111], v[236:239], a[28:31], v[108:111]
    ds_read_b128 a[12:15], v247 offset:6144
    v_perm_b32 v231, v158, v154, s81
    v_mfma_f32_16x16x32_bf16 v[16:19], v[224:227], a[16:19], v[16:19]
    v_perm_b32 v232, v135, v131, s80
    v_mfma_f32_16x16x32_bf16 v[48:51], v[224:227], a[20:23], v[48:51]
    buffer_load_dwordx4 v[208:211], v244, s[48:51], s76 offen
    v_perm_b32 v233, v143, v139, s80
    v_mfma_f32_16x16x32_bf16 v[80:83], v[224:227], a[24:27], v[80:83]
    v_perm_b32 v234, v151, v147, s80
    v_mfma_f32_16x16x32_bf16 v[112:115], v[224:227], a[28:31], v[112:115]
    v_perm_b32 v235, v159, v155, s80
    v_mfma_f32_16x16x32_bf16 v[20:23], v[228:231], a[16:19], v[20:23]
    v_perm_b32 v236, v135, v131, s81
    v_mfma_f32_16x16x32_bf16 v[52:55], v[228:231], a[20:23], v[52:55]
    buffer_load_dwordx4 v[212:215], v244, s[48:51], s77 offen
    v_perm_b32 v237, v143, v139, s81
    v_mfma_f32_16x16x32_bf16 v[84:87], v[228:231], a[24:27], v[84:87]
    v_perm_b32 v238, v151, v147, s81
    v_mfma_f32_16x16x32_bf16 v[116:119], v[228:231], a[28:31], v[116:119]
    v_perm_b32 v239, v159, v155, s81
    v_mfma_f32_16x16x32_bf16 v[24:27], v[232:235], a[16:19], v[24:27]
    s_waitcnt vmcnt(6)
    v_perm_b32 v224, v164, v160, s80
    v_mfma_f32_16x16x32_bf16 v[56:59], v[232:235], a[20:23], v[56:59]
    buffer_load_dwordx4 v[216:219], v244, s[48:51], s78 offen
    v_perm_b32 v225, v172, v168, s80
    v_mfma_f32_16x16x32_bf16 v[88:91], v[232:235], a[24:27], v[88:91]
    v_perm_b32 v226, v180, v176, s80
    v_mfma_f32_16x16x32_bf16 v[120:123], v[232:235], a[28:31], v[120:123]
    v_perm_b32 v227, v188, v184, s80
    v_mfma_f32_16x16x32_bf16 v[28:31], v[236:239], a[16:19], v[28:31]
    v_perm_b32 v228, v164, v160, s81
    v_mfma_f32_16x16x32_bf16 v[60:63], v[236:239], a[20:23], v[60:63]
    buffer_load_dwordx4 v[220:223], v244, s[48:51], s79 offen
    v_perm_b32 v229, v172, v168, s81
    v_mfma_f32_16x16x32_bf16 v[92:95], v[236:239], a[24:27], v[92:95]
    v_perm_b32 v230, v180, v176, s81
    v_mfma_f32_16x16x32_bf16 v[124:127], v[236:239], a[28:31], v[124:127]
    v_perm_b32 v231, v188, v184, s81
    s_cmp_eq_u32 s85, 1
    s_cbranch_scc0 L_b3
    s_barrier
    s_cmp_eq_u32 s68, 0
    s_cbranch_scc0 L_b3_n
    v_accvgpr_read_b32 v232, a88
    v_accvgpr_read_b32 v233, a89
    v_accvgpr_read_b32 v234, a90
    v_accvgpr_read_b32 v235, a91
    v_readfirstlane_b32 s70, v232
L_b3_l:
    s_nop 0
    s_add_u32 s70, s70, 1
    s_cbranch_scc1 L_b3_l
    v_cmp_eq_u32 vcc, s70, v232
    v_cmp_eq_u32 s[94:95], s70, v233
    v_cmp_eq_u32 s[96:97], s70, v234
    s_or_b64 s[94:95], s[94:95], vcc
    v_cmp_eq_u32 vcc, s70, v235
    s_or_b64 s[94:95], s[94:95], s[96:97]
    s_or_b64 s[94:95], s[94:95], vcc
    s_cbranch_scc1 L_b3_l
    v_mov_b32 v236, s70
    s_mov_b64 exec, 1
    buffer_store_dword v236, off, s[28:31], s3 sc1
    s_mov_b64 exec, -1
L_b3_n:
    s_add_u32 m0, s23, 16384
    s_add_u32 s69, s22, 256
    buffer_load_dwordx4 v251, s[36:39], s69 offen lds
    s_add_u32 m0, s23, 24576
    s_add_u32 s69, s22, 384
    buffer_load_dwordx4 v251, s[36:39], s69 offen lds
    s_add_u32 m0, s23, 40960
    s_add_u32 s69, s22, 640
    buffer_load_dwordx4 v251, s[36:39], s69 offen lds
    s_add_u32 m0, s23, 49152
    s_add_u32 s69, s22, 768
    buffer_load_dwordx4 v251, s[36:39], s69 offen lds
    s_add_u32 m0, s23, 57344
    s_add_u32 s69, s22, 896
    buffer_load_dwordx4 v251, s[36:39], s69 offen lds
    s_add_u32 m0, s23, 65536
    s_add_u32 s69, s22, 1024
    buffer_load_dwordx4 v251, s[36:39], s69 offen lds
    s_add_u32 m0, s88, 0
    s_nop 0
    buffer_load_dwordx4 v249, s[40:43], 0 offen offset:0 nt lds
    buffer_load_dwordx4 v249, s[40:43], 0 offen offset:1024 nt lds
    s_add_u32 m0, s88, 128
    s_nop 0
    buffer_load_dwordx4 v249, s[40:43], 0 offen offset:2048 nt lds
    buffer_load_dwordx4 v249, s[40:43], 0 offen offset:3072 nt lds
    s_add_u32 m0, s88, 4352
    s_nop 0
    buffer_load_dwordx4 v249, s[40:43], s86 offen offset:0 nt lds
    buffer_load_dwordx4 v249, s[40:43], s86 offen offset:1024 nt lds
    s_add_u32 m0, s88, 4480
    s_nop 0
    buffer_load_dwordx4 v249, s[40:43], s86 offen offset:2048 nt lds
    buffer_load_dwordx4 v249, s[40:43], s86 offen offset:3072 nt lds
L_b3:
    s_cmp_eq_u32 s85, 1
    s_cbranch_scc0 L_b4
    s_barrier
    s_add_u32 m0, s88, 8704
    s_nop 0
    buffer_load_dwordx4 v249, s[40:43], s73 offen offset:0 nt lds
    buffer_load_dwordx4 v249, s[40:43], s73 offen offset:1024 nt lds
    s_add_u32 m0, s88, 8832
    s_nop 0
    buffer_load_dwordx4 v249, s[40:43], s73 offen offset:2048 nt lds
    buffer_load_dwordx4 v249, s[40:43], s73 offen offset:3072 nt lds
    s_add_u32 m0, s88, 13056
    s_nop 0
    buffer_load_dwordx4 v249, s[40:43], s87 offen offset:0 nt lds
    buffer_load_dwordx4 v249, s[40:43], s87 offen offset:1024 nt lds
    s_add_u32 m0, s88, 13184
    s_nop 0
    buffer_load_dwordx4 v249, s[40:43], s87 offen offset:2048 nt lds
    buffer_load_dwordx4 v249, s[40:43], s87 offen offset:3072 nt lds
L_b4:
    s_cmp_eq_u32 s85, 1
    s_cbranch_scc0 L_b5
    s_barrier
    buffer_load_dwordx4 a[32:35], v250, s[44:47], 0 offen offset:0 nt
    buffer_load_dwordx4 a[36:39], v250, s[44:47], 0 offen offset:1024 nt
    buffer_load_dwordx4 a[40:43], v250, s[44:47], 0 offen offset:2048 nt
    buffer_load_dwordx4 a[44:47], v250, s[44:47], 0 offen offset:3072 nt
    buffer_load_dwordx4 a[48:51], v250, s[44:47], s86 offen offset:0 nt
    buffer_load_dwordx4 a[52:55], v250, s[44:47], s86 offen offset:1024 nt
    buffer_load_dwordx4 a[56:59], v250, s[44:47], s86 offen offset:2048 nt
    buffer_load_dwordx4 a[60:63], v250, s[44:47], s86 offen offset:3072 nt
    s_add_u32 m0, s25, 16384
    s_add_u32 s69, s24, 256
    buffer_load_dwordx4 v251, s[36:39], s69 offen lds
    s_add_u32 m0, s25, 24576
    s_add_u32 s69, s24, 384
    buffer_load_dwordx4 v251, s[36:39], s69 offen lds
    s_add_u32 m0, s25, 40960
    s_add_u32 s69, s24, 640
    buffer_load_dwordx4 v251, s[36:39], s69 offen lds
    s_add_u32 m0, s25, 49152
    s_add_u32 s69, s24, 768
    buffer_load_dwordx4 v251, s[36:39], s69 offen lds
    s_add_u32 m0, s25, 57344
    s_add_u32 s69, s24, 896
    buffer_load_dwordx4 v251, s[36:39], s69 offen lds
    s_add_u32 m0, s25, 65536
    s_add_u32 s69, s24, 1024
    buffer_load_dwordx4 v251, s[36:39], s69 offen lds
L_b5:
    s_waitcnt lgkmcnt(0)
    v_mfma_f32_16x16x32_bf16 v[0:3], v[224:227], a[0:3], v[0:3]
    s_lshr_b64 s[6:7], s[6:7], 4
    s_and_b32 s82, s6, 15
    s_lshl_b32 s83, s82, 19
    v_perm_b32 v232, v165, v161, s80
    v_add_u32 v243, s83, v241
    v_mfma_f32_16x16x32_bf16 v[32:35], v[224:227], a[4:7], v[32:35]
    buffer_load_dwordx4 v[128:131], v243, s[48:51], 0 offen
    v_perm_b32 v233, v173, v169, s80
    v_mfma_f32_16x16x32_bf16 v[64:67], v[224:227], a[8:11], v[64:67]
    v_perm_b32 v234, v181, v177, s80
    v_mfma_f32_16x16x32_bf16 v[96:99], v[224:227], a[12:15], v[96:99]
    ds_read_b128 a[16:19], v248 offset:0
    v_perm_b32 v235, v189, v185, s80
    v_mfma_f32_16x16x32_bf16 v[4:7], v[228:231], a[0:3], v[4:7]
    v_perm_b32 v236, v165, v161, s81
    v_add_u32 v244, s83, v242
    v_mfma_f32_16x16x32_bf16 v[36:39], v[228:231], a[4:7], v[36:39]
    buffer_load_dwordx4 v[132:135], v243, s[48:51], s73 offen
    v_perm_b32 v237, v173, v169, s81
    v_mfma_f32_16x16x32_bf16 v[68:71], v[228:231], a[8:11], v[68:71]
    s_lshl_b32 s84, s82, 13
    v_perm_b32 v238, v181, v177, s81
    v_mfma_f32_16x16x32_bf16 v[100:103], v[228:231], a[12:15], v[100:103]
    ds_read_b128 a[20:23], v248 offset:2048
    v_perm_b32 v239, v189, v185, s81
    v_mfma_f32_16x16x32_bf16 v[8:11], v[232:235], a[0:3], v[8:11]
    v_perm_b32 v224, v166, v162, s80
    v_add_u32 v247, s84, v245
    v_mfma_f32_16x16x32_bf16 v[40:43], v[232:235], a[4:7], v[40:43]
    buffer_load_dwordx4 v[136:139], v243, s[48:51], s74 offen
    v_perm_b32 v225, v174, v170, s80
    v_mfma_f32_16x16x32_bf16 v[72:75], v[232:235], a[8:11], v[72:75]
    v_perm_b32 v226, v182, v178, s80
    v_mfma_f32_16x16x32_bf16 v[104:107], v[232:235], a[12:15], v[104:107]
    ds_read_b128 a[24:27], v248 offset:4096
    v_perm_b32 v227, v190, v186, s80
    v_mfma_f32_16x16x32_bf16 v[12:15], v[236:239], a[0:3], v[12:15]
    v_perm_b32 v228, v166, v162, s81
    v_mfma_f32_16x16x32_bf16 v[44:47], v[236:239], a[4:7], v[44:47]
    buffer_load_dwordx4 v[140:143], v243, s[48:51], s75 offen
    v_perm_b32 v229, v174, v170, s81
    v_mfma_f32_16x16x32_bf16 v[76:79], v[236:239], a[8:11], v[76:79]
    v_perm_b32 v230, v182, v178, s81
    v_mfma_f32_16x16x32_bf16 v[108:111], v[236:239], a[12:15], v[108:111]
    ds_read_b128 a[28:31], v248 offset:6144
    v_perm_b32 v231, v190, v186, s81
    v_mfma_f32_16x16x32_bf16 v[16:19], v[224:227], a[0:3], v[16:19]
    v_perm_b32 v232, v167, v163, s80
    v_mfma_f32_16x16x32_bf16 v[48:51], v[224:227], a[4:7], v[48:51]
    buffer_load_dwordx4 v[144:147], v243, s[48:51], s76 offen
    v_perm_b32 v233, v175, v171, s80
    v_mfma_f32_16x16x32_bf16 v[80:83], v[224:227], a[8:11], v[80:83]
    v_perm_b32 v234, v183, v179, s80
    v_mfma_f32_16x16x32_bf16 v[112:115], v[224:227], a[12:15], v[112:115]
    v_perm_b32 v235, v191, v187, s80
    v_mfma_f32_16x16x32_bf16 v[20:23], v[228:231], a[0:3], v[20:23]
    v_perm_b32 v236, v167, v163, s81
    v_mfma_f32_16x16x32_bf16 v[52:55], v[228:231], a[4:7], v[52:55]
    buffer_load_dwordx4 v[148:151], v243, s[48:51], s77 offen
    v_perm_b32 v237, v175, v171, s81
    v_mfma_f32_16x16x32_bf16 v[84:87], v[228:231], a[8:11], v[84:87]
    v_perm_b32 v238, v183, v179, s81
    v_mfma_f32_16x16x32_bf16 v[116:119], v[228:231], a[12:15], v[116:119]
    v_perm_b32 v239, v191, v187, s81
    v_mfma_f32_16x16x32_bf16 v[24:27], v[232:235], a[0:3], v[24:27]
    s_waitcnt vmcnt(6)
    v_perm_b32 v224, v196, v192, s80
    v_mfma_f32_16x16x32_bf16 v[56:59], v[232:235], a[4:7], v[56:59]
    buffer_load_dwordx4 v[152:155], v243, s[48:51], s78 offen
    v_perm_b32 v225, v204, v200, s80
    v_mfma_f32_16x16x32_bf16 v[88:91], v[232:235], a[8:11], v[88:91]
    v_perm_b32 v226, v212, v208, s80
    v_mfma_f32_16x16x32_bf16 v[120:123], v[232:235], a[12:15], v[120:123]
    v_perm_b32 v227, v220, v216, s80
    v_mfma_f32_16x16x32_bf16 v[28:31], v[236:239], a[0:3], v[28:31]
    v_perm_b32 v228, v196, v192, s81
    v_mfma_f32_16x16x32_bf16 v[60:63], v[236:239], a[4:7], v[60:63]
    buffer_load_dwordx4 v[156:159], v243, s[48:51], s79 offen
    v_perm_b32 v229, v204, v200, s81
    v_mfma_f32_16x16x32_bf16 v[92:95], v[236:239], a[8:11], v[92:95]
    v_perm_b32 v230, v212, v208, s81
    v_mfma_f32_16x16x32_bf16 v[124:127], v[236:239], a[12:15], v[124:127]
    v_perm_b32 v231, v220, v216, s81
    s_bitcmp0_b32 s2, 7
    s_cbranch_scc0 L_xb
    s_waitcnt vmcnt(8)
    s_barrier
L_xb:
    s_waitcnt lgkmcnt(0)
    v_mfma_f32_16x16x32_bf16 v[0:3], v[224:227], a[16:19], v[0:3]
    v_perm_b32 v232, v197, v193, s80
    v_add_u32 v248, s84, v246
    v_mfma_f32_16x16x32_bf16 v[32:35], v[224:227], a[20:23], v[32:35]
    buffer_load_dwordx4 v[160:163], v244, s[48:51], 0 offen
    v_perm_b32 v233, v205, v201, s80
    v_mfma_f32_16x16x32_bf16 v[64:67], v[224:227], a[24:27], v[64:67]
    v_perm_b32 v234, v213, v209, s80
    v_mfma_f32_16x16x32_bf16 v[96:99], v[224:227], a[28:31], v[96:99]
    ds_read_b128 a[0:3], v247 offset:0
    v_perm_b32 v235, v221, v217, s80
    v_mfma_f32_16x16x32_bf16 v[4:7], v[228:231], a[16:19], v[4:7]
    v_perm_b32 v236, v197, v193, s81
    v_mfma_f32_16x16x32_bf16 v[36:39], v[228:231], a[20:23], v[36:39]
    buffer_load_dwordx4 v[164:167], v244, s[48:51], s73 offen
    v_perm_b32 v237, v205, v201, s81
    v_mfma_f32_16x16x32_bf16 v[68:71], v[228:231], a[24:27], v[68:71]
    v_perm_b32 v238, v213, v209, s81
    v_mfma_f32_16x16x32_bf16 v[100:103], v[228:231], a[28:31], v[100:103]
    ds_read_b128 a[4:7], v247 offset:2048
    v_perm_b32 v239, v221, v217, s81
    v_mfma_f32_16x16x32_bf16 v[8:11], v[232:235], a[16:19], v[8:11]
    v_perm_b32 v224, v198, v194, s80
    v_mfma_f32_16x16x32_bf16 v[40:43], v[232:235], a[20:23], v[40:43]
    buffer_load_dwordx4 v[168:171], v244, s[48:51], s74 offen
    v_perm_b32 v225, v206, v202, s80
    v_mfma_f32_16x16x32_bf16 v[72:75], v[232:235], a[24:27], v[72:75]
    v_perm_b32 v226, v214, v210, s80
    v_mfma_f32_16x16x32_bf16 v[104:107], v[232:235], a[28:31], v[104:107]
    ds_read_b128 a[8:11], v247 offset:4096
    v_perm_b32 v227, v222, v218, s80
    v_mfma_f32_16x16x32_bf16 v[12:15], v[236:239], a[16:19], v[12:15]
    v_perm_b32 v228, v198, v194, s81
    v_mfma_f32_16x16x32_bf16 v[44:47], v[236:239], a[20:23], v[44:47]
    buffer_load_dwordx4 v[172:175], v244, s[48:51], s75 offen
    v_perm_b32 v229, v206, v202, s81
    v_mfma_f32_16x16x32_bf16 v[76:79], v[236:239], a[24:27], v[76:79]
    v_perm_b32 v230, v214, v210, s81
    v_mfma_f32_16x16x32_bf16 v[108:111], v[236:239], a[28:31], v[108:111]
    ds_read_b128 a[12:15], v247 offset:6144
    v_perm_b32 v231, v222, v218, s81
    v_mfma_f32_16x16x32_bf16 v[16:19], v[224:227], a[16:19], v[16:19]
    v_perm_b32 v232, v199, v195, s80
    v_mfma_f32_16x16x32_bf16 v[48:51], v[224:227], a[20:23], v[48:51]
    buffer_load_dwordx4 v[176:179], v244, s[48:51], s76 offen
    v_perm_b32 v233, v207, v203, s80
    v_mfma_f32_16x16x32_bf16 v[80:83], v[224:227], a[24:27], v[80:83]
    v_perm_b32 v234, v215, v211, s80
    v_mfma_f32_16x16x32_bf16 v[112:115], v[224:227], a[28:31], v[112:115]
    v_perm_b32 v235, v223, v219, s80
    v_mfma_f32_16x16x32_bf16 v[20:23], v[228:231], a[16:19], v[20:23]
    v_perm_b32 v236, v199, v195, s81
    v_mfma_f32_16x16x32_bf16 v[52:55], v[228:231], a[20:23], v[52:55]
    buffer_load_dwordx4 v[180:183], v244, s[48:51], s77 offen
    v_perm_b32 v237, v207, v203, s81
    v_mfma_f32_16x16x32_bf16 v[84:87], v[228:231], a[24:27], v[84:87]
    v_perm_b32 v238, v215, v211, s81
    v_mfma_f32_16x16x32_bf16 v[116:119], v[228:231], a[28:31], v[116:119]
    v_perm_b32 v239, v223, v219, s81
    v_mfma_f32_16x16x32_bf16 v[24:27], v[232:235], a[16:19], v[24:27]
    s_waitcnt vmcnt(6)
    v_perm_b32 v224, v132, v128, s80
    v_mfma_f32_16x16x32_bf16 v[56:59], v[232:235], a[20:23], v[56:59]
    buffer_load_dwordx4 v[184:187], v244, s[48:51], s78 offen
    v_perm_b32 v225, v140, v136, s80
    v_mfma_f32_16x16x32_bf16 v[88:91], v[232:235], a[24:27], v[88:91]
    v_perm_b32 v226, v148, v144, s80
    v_mfma_f32_16x16x32_bf16 v[120:123], v[232:235], a[28:31], v[120:123]
    v_perm_b32 v227, v156, v152, s80
    v_mfma_f32_16x16x32_bf16 v[28:31], v[236:239], a[16:19], v[28:31]
    v_perm_b32 v228, v132, v128, s81
    v_mfma_f32_16x16x32_bf16 v[60:63], v[236:239], a[20:23], v[60:63]
    buffer_load_dwordx4 v[188:191], v244, s[48:51], s79 offen
    v_perm_b32 v229, v140, v136, s81
    v_mfma_f32_16x16x32_bf16 v[92:95], v[236:239], a[24:27], v[92:95]
    v_perm_b32 v230, v148, v144, s81
    v_mfma_f32_16x16x32_bf16 v[124:127], v[236:239], a[28:31], v[124:127]
    v_perm_b32 v231, v156, v152, s81
    s_waitcnt lgkmcnt(0)
    v_mfma_f32_16x16x32_bf16 v[0:3], v[224:227], a[0:3], v[0:3]
    s_lshr_b64 s[6:7], s[6:7], 4
    s_and_b32 s82, s6, 15
    s_lshl_b32 s83, s82, 19
    v_perm_b32 v232, v133, v129, s80
    v_add_u32 v243, s83, v241
    v_mfma_f32_16x16x32_bf16 v[32:35], v[224:227], a[4:7], v[32:35]
    buffer_load_dwordx4 v[192:195], v243, s[48:51], 0 offen
    v_perm_b32 v233, v141, v137, s80
    v_mfma_f32_16x16x32_bf16 v[64:67], v[224:227], a[8:11], v[64:67]
    v_perm_b32 v234, v149, v145, s80
    v_mfma_f32_16x16x32_bf16 v[96:99], v[224:227], a[12:15], v[96:99]
    ds_read_b128 a[16:19], v248 offset:0
    v_perm_b32 v235, v157, v153, s80
    v_mfma_f32_16x16x32_bf16 v[4:7], v[228:231], a[0:3], v[4:7]
    v_perm_b32 v236, v133, v129, s81
    v_add_u32 v244, s83, v242
    v_mfma_f32_16x16x32_bf16 v[36:39], v[228:231], a[4:7], v[36:39]
    buffer_load_dwordx4 v[196:199], v243, s[48:51], s73 offen
    v_perm_b32 v237, v141, v137, s81
    v_mfma_f32_16x16x32_bf16 v[68:71], v[228:231], a[8:11], v[68:71]
    s_lshl_b32 s84, s82, 13
    v_perm_b32 v238, v149, v145, s81
    v_mfma_f32_16x16x32_bf16 v[100:103], v[228:231], a[12:15], v[100:103]
    ds_read_b128 a[20:23], v248 offset:2048
    v_perm_b32 v239, v157, v153, s81
    v_mfma_f32_16x16x32_bf16 v[8:11], v[232:235], a[0:3], v[8:11]
    v_perm_b32 v224, v134, v130, s80
    v_add_u32 v247, s84, v245
    v_mfma_f32_16x16x32_bf16 v[40:43], v[232:235], a[4:7], v[40:43]
    buffer_load_dwordx4 v[200:203], v243, s[48:51], s74 offen
    v_perm_b32 v225, v142, v138, s80
    v_mfma_f32_16x16x32_bf16 v[72:75], v[232:235], a[8:11], v[72:75]
    v_perm_b32 v226, v150, v146, s80
    v_mfma_f32_16x16x32_bf16 v[104:107], v[232:235], a[12:15], v[104:107]
    ds_read_b128 a[24:27], v248 offset:4096
    v_perm_b32 v227, v158, v154, s80
    v_mfma_f32_16x16x32_bf16 v[12:15], v[236:239], a[0:3], v[12:15]
    v_perm_b32 v228, v134, v130, s81
    v_mfma_f32_16x16x32_bf16 v[44:47], v[236:239], a[4:7], v[44:47]
    buffer_load_dwordx4 v[204:207], v243, s[48:51], s75 offen
    v_perm_b32 v229, v142, v138, s81
    v_mfma_f32_16x16x32_bf16 v[76:79], v[236:239], a[8:11], v[76:79]
    v_perm_b32 v230, v150, v146, s81
    v_mfma_f32_16x16x32_bf16 v[108:111], v[236:239], a[12:15], v[108:111]
    ds_read_b128 a[28:31], v248 offset:6144
    v_perm_b32 v231, v158, v154, s81
    v_mfma_f32_16x16x32_bf16 v[16:19], v[224:227], a[0:3], v[16:19]
    v_perm_b32 v232, v135, v131, s80
    v_mfma_f32_16x16x32_bf16 v[48:51], v[224:227], a[4:7], v[48:51]
    buffer_load_dwordx4 v[208:211], v243, s[48:51], s76 offen
    v_perm_b32 v233, v143, v139, s80
    v_mfma_f32_16x16x32_bf16 v[80:83], v[224:227], a[8:11], v[80:83]
    v_perm_b32 v234, v151, v147, s80
    v_mfma_f32_16x16x32_bf16 v[112:115], v[224:227], a[12:15], v[112:115]
    v_perm_b32 v235, v159, v155, s80
    v_mfma_f32_16x16x32_bf16 v[20:23], v[228:231], a[0:3], v[20:23]
    v_perm_b32 v236, v135, v131, s81
    v_mfma_f32_16x16x32_bf16 v[52:55], v[228:231], a[4:7], v[52:55]
    buffer_load_dwordx4 v[212:215], v243, s[48:51], s77 offen
    v_perm_b32 v237, v143, v139, s81
    v_mfma_f32_16x16x32_bf16 v[84:87], v[228:231], a[8:11], v[84:87]
    v_perm_b32 v238, v151, v147, s81
    v_mfma_f32_16x16x32_bf16 v[116:119], v[228:231], a[12:15], v[116:119]
    v_perm_b32 v239, v159, v155, s81
    v_mfma_f32_16x16x32_bf16 v[24:27], v[232:235], a[0:3], v[24:27]
    s_waitcnt vmcnt(6)
    v_perm_b32 v224, v164, v160, s80
    v_mfma_f32_16x16x32_bf16 v[56:59], v[232:235], a[4:7], v[56:59]
    buffer_load_dwordx4 v[216:219], v243, s[48:51], s78 offen
    v_perm_b32 v225, v172, v168, s80
    v_mfma_f32_16x16x32_bf16 v[88:91], v[232:235], a[8:11], v[88:91]
    v_perm_b32 v226, v180, v176, s80
    v_mfma_f32_16x16x32_bf16 v[120:123], v[232:235], a[12:15], v[120:123]
    v_perm_b32 v227, v188, v184, s80
    v_mfma_f32_16x16x32_bf16 v[28:31], v[236:239], a[0:3], v[28:31]
    v_perm_b32 v228, v164, v160, s81
    v_mfma_f32_16x16x32_bf16 v[60:63], v[236:239], a[4:7], v[60:63]
    buffer_load_dwordx4 v[220:223], v243, s[48:51], s79 offen
    v_perm_b32 v229, v172, v168, s81
    v_mfma_f32_16x16x32_bf16 v[92:95], v[236:239], a[8:11], v[92:95]
    v_perm_b32 v230, v180, v176, s81
    v_mfma_f32_16x16x32_bf16 v[124:127], v[236:239], a[12:15], v[124:127]
    v_perm_b32 v231, v188, v184, s81
    s_waitcnt lgkmcnt(0)
    v_mfma_f32_16x16x32_bf16 v[0:3], v[224:227], a[16:19], v[0:3]
    v_perm_b32 v232, v165, v161, s80
    v_add_u32 v248, s84, v246
    v_mfma_f32_16x16x32_bf16 v[32:35], v[224:227], a[20:23], v[32:35]
    buffer_load_dwordx4 v[128:131], v244, s[48:51], 0 offen
    v_perm_b32 v233, v173, v169, s80
    v_mfma_f32_16x16x32_bf16 v[64:67], v[224:227], a[24:27], v[64:67]
    v_perm_b32 v234, v181, v177, s80
    v_mfma_f32_16x16x32_bf16 v[96:99], v[224:227], a[28:31], v[96:99]
    ds_read_b128 a[0:3], v247 offset:0
    v_perm_b32 v235, v189, v185, s80
    v_mfma_f32_16x16x32_bf16 v[4:7], v[228:231], a[16:19], v[4:7]
    v_perm_b32 v236, v165, v161, s81
    v_mfma_f32_16x16x32_bf16 v[36:39], v[228:231], a[20:23], v[36:39]
    buffer_load_dwordx4 v[132:135], v244, s[48:51], s73 offen
    v_perm_b32 v237, v173, v169, s81
    v_mfma_f32_16x16x32_bf16 v[68:71], v[228:231], a[24:27], v[68:71]
    v_perm_b32 v238, v181, v177, s81
    v_mfma_f32_16x16x32_bf16 v[100:103], v[228:231], a[28:31], v[100:103]
    ds_read_b128 a[4:7], v247 offset:2048
    v_perm_b32 v239, v189, v185, s81
    v_mfma_f32_16x16x32_bf16 v[8:11], v[232:235], a[16:19], v[8:11]
    v_perm_b32 v224, v166, v162, s80
    v_mfma_f32_16x16x32_bf16 v[40:43], v[232:235], a[20:23], v[40:43]
    buffer_load_dwordx4 v[136:139], v244, s[48:51], s74 offen
    v_perm_b32 v225, v174, v170, s80
    v_mfma_f32_16x16x32_bf16 v[72:75], v[232:235], a[24:27], v[72:75]
    v_perm_b32 v226, v182, v178, s80
    v_mfma_f32_16x16x32_bf16 v[104:107], v[232:235], a[28:31], v[104:107]
    ds_read_b128 a[8:11], v247 offset:4096
    v_perm_b32 v227, v190, v186, s80
    v_mfma_f32_16x16x32_bf16 v[12:15], v[236:239], a[16:19], v[12:15]
    v_perm_b32 v228, v166, v162, s81
    v_mfma_f32_16x16x32_bf16 v[44:47], v[236:239], a[20:23], v[44:47]
    buffer_load_dwordx4 v[140:143], v244, s[48:51], s75 offen
    v_perm_b32 v229, v174, v170, s81
    v_mfma_f32_16x16x32_bf16 v[76:79], v[236:239], a[24:27], v[76:79]
    v_perm_b32 v230, v182, v178, s81
    v_mfma_f32_16x16x32_bf16 v[108:111], v[236:239], a[28:31], v[108:111]
    ds_read_b128 a[12:15], v247 offset:6144
    v_perm_b32 v231, v190, v186, s81
    v_mfma_f32_16x16x32_bf16 v[16:19], v[224:227], a[16:19], v[16:19]
    v_perm_b32 v232, v167, v163, s80
    v_mfma_f32_16x16x32_bf16 v[48:51], v[224:227], a[20:23], v[48:51]
    buffer_load_dwordx4 v[144:147], v244, s[48:51], s76 offen
    v_perm_b32 v233, v175, v171, s80
    v_mfma_f32_16x16x32_bf16 v[80:83], v[224:227], a[24:27], v[80:83]
    v_perm_b32 v234, v183, v179, s80
    v_mfma_f32_16x16x32_bf16 v[112:115], v[224:227], a[28:31], v[112:115]
    v_perm_b32 v235, v191, v187, s80
    v_mfma_f32_16x16x32_bf16 v[20:23], v[228:231], a[16:19], v[20:23]
    v_perm_b32 v236, v167, v163, s81
    v_mfma_f32_16x16x32_bf16 v[52:55], v[228:231], a[20:23], v[52:55]
    buffer_load_dwordx4 v[148:151], v244, s[48:51], s77 offen
    v_perm_b32 v237, v175, v171, s81
    v_mfma_f32_16x16x32_bf16 v[84:87], v[228:231], a[24:27], v[84:87]
    v_perm_b32 v238, v183, v179, s81
    v_mfma_f32_16x16x32_bf16 v[116:119], v[228:231], a[28:31], v[116:119]
    v_perm_b32 v239, v191, v187, s81
    v_mfma_f32_16x16x32_bf16 v[24:27], v[232:235], a[16:19], v[24:27]
    s_waitcnt vmcnt(6)
    v_perm_b32 v224, v196, v192, s80
    v_mfma_f32_16x16x32_bf16 v[56:59], v[232:235], a[20:23], v[56:59]
    buffer_load_dwordx4 v[152:155], v244, s[48:51], s78 offen
    v_perm_b32 v225, v204, v200, s80
    v_mfma_f32_16x16x32_bf16 v[88:91], v[232:235], a[24:27], v[88:91]
    v_perm_b32 v226, v212, v208, s80
    v_mfma_f32_16x16x32_bf16 v[120:123], v[232:235], a[28:31], v[120:123]
    v_perm_b32 v227, v220, v216, s80
    v_mfma_f32_16x16x32_bf16 v[28:31], v[236:239], a[16:19], v[28:31]
    v_perm_b32 v228, v196, v192, s81
    v_mfma_f32_16x16x32_bf16 v[60:63], v[236:239], a[20:23], v[60:63]
    buffer_load_dwordx4 v[156:159], v244, s[48:51], s79 offen
    v_perm_b32 v229, v204, v200, s81
    v_mfma_f32_16x16x32_bf16 v[92:95], v[236:239], a[24:27], v[92:95]
    v_perm_b32 v230, v212, v208, s81
    v_mfma_f32_16x16x32_bf16 v[124:127], v[236:239], a[28:31], v[124:127]
    v_perm_b32 v231, v220, v216, s81
    s_waitcnt lgkmcnt(0)
    v_mfma_f32_16x16x32_bf16 v[0:3], v[224:227], a[0:3], v[0:3]
    s_lshr_b64 s[6:7], s[6:7], 4
    s_and_b32 s82, s6, 15
    s_lshl_b32 s83, s82, 19
    v_perm_b32 v232, v197, v193, s80
    v_add_u32 v243, s83, v241
    v_mfma_f32_16x16x32_bf16 v[32:35], v[224:227], a[4:7], v[32:35]
    buffer_load_dwordx4 v[160:163], v243, s[48:51], 0 offen
    v_perm_b32 v233, v205, v201, s80
    v_mfma_f32_16x16x32_bf16 v[64:67], v[224:227], a[8:11], v[64:67]
    v_perm_b32 v234, v213, v209, s80
    v_mfma_f32_16x16x32_bf16 v[96:99], v[224:227], a[12:15], v[96:99]
    ds_read_b128 a[16:19], v248 offset:0
    v_perm_b32 v235, v221, v217, s80
    v_mfma_f32_16x16x32_bf16 v[4:7], v[228:231], a[0:3], v[4:7]
    v_perm_b32 v236, v197, v193, s81
    v_add_u32 v244, s83, v242
    v_mfma_f32_16x16x32_bf16 v[36:39], v[228:231], a[4:7], v[36:39]
    buffer_load_dwordx4 v[164:167], v243, s[48:51], s73 offen
    v_perm_b32 v237, v205, v201, s81
    v_mfma_f32_16x16x32_bf16 v[68:71], v[228:231], a[8:11], v[68:71]
    s_lshl_b32 s84, s82, 13
    v_perm_b32 v238, v213, v209, s81
    v_mfma_f32_16x16x32_bf16 v[100:103], v[228:231], a[12:15], v[100:103]
    ds_read_b128 a[20:23], v248 offset:2048
    v_perm_b32 v239, v221, v217, s81
    v_mfma_f32_16x16x32_bf16 v[8:11], v[232:235], a[0:3], v[8:11]
    v_perm_b32 v224, v198, v194, s80
    v_add_u32 v247, s84, v245
    v_mfma_f32_16x16x32_bf16 v[40:43], v[232:235], a[4:7], v[40:43]
    buffer_load_dwordx4 v[168:171], v243, s[48:51], s74 offen
    v_perm_b32 v225, v206, v202, s80
    v_mfma_f32_16x16x32_bf16 v[72:75], v[232:235], a[8:11], v[72:75]
    v_perm_b32 v226, v214, v210, s80
    v_mfma_f32_16x16x32_bf16 v[104:107], v[232:235], a[12:15], v[104:107]
    ds_read_b128 a[24:27], v248 offset:4096
    v_perm_b32 v227, v222, v218, s80
    v_mfma_f32_16x16x32_bf16 v[12:15], v[236:239], a[0:3], v[12:15]
    v_perm_b32 v228, v198, v194, s81
    v_mfma_f32_16x16x32_bf16 v[44:47], v[236:239], a[4:7], v[44:47]
    buffer_load_dwordx4 v[172:175], v243, s[48:51], s75 offen
    v_perm_b32 v229, v206, v202, s81
    v_mfma_f32_16x16x32_bf16 v[76:79], v[236:239], a[8:11], v[76:79]
    v_perm_b32 v230, v214, v210, s81
    v_mfma_f32_16x16x32_bf16 v[108:111], v[236:239], a[12:15], v[108:111]
    ds_read_b128 a[28:31], v248 offset:6144
    v_perm_b32 v231, v222, v218, s81
    v_mfma_f32_16x16x32_bf16 v[16:19], v[224:227], a[0:3], v[16:19]
    v_perm_b32 v232, v199, v195, s80
    v_mfma_f32_16x16x32_bf16 v[48:51], v[224:227], a[4:7], v[48:51]
    buffer_load_dwordx4 v[176:179], v243, s[48:51], s76 offen
    v_perm_b32 v233, v207, v203, s80
    v_mfma_f32_16x16x32_bf16 v[80:83], v[224:227], a[8:11], v[80:83]
    v_perm_b32 v234, v215, v211, s80
    v_mfma_f32_16x16x32_bf16 v[112:115], v[224:227], a[12:15], v[112:115]
    v_perm_b32 v235, v223, v219, s80
    v_mfma_f32_16x16x32_bf16 v[20:23], v[228:231], a[0:3], v[20:23]
    v_perm_b32 v236, v199, v195, s81
    v_mfma_f32_16x16x32_bf16 v[52:55], v[228:231], a[4:7], v[52:55]
    buffer_load_dwordx4 v[180:183], v243, s[48:51], s77 offen
    v_perm_b32 v237, v207, v203, s81
    v_mfma_f32_16x16x32_bf16 v[84:87], v[228:231], a[8:11], v[84:87]
    v_perm_b32 v238, v215, v211, s81
    v_mfma_f32_16x16x32_bf16 v[116:119], v[228:231], a[12:15], v[116:119]
    v_perm_b32 v239, v223, v219, s81
    v_mfma_f32_16x16x32_bf16 v[24:27], v[232:235], a[0:3], v[24:27]
    s_waitcnt vmcnt(6)
    v_perm_b32 v224, v132, v128, s80
    v_mfma_f32_16x16x32_bf16 v[56:59], v[232:235], a[4:7], v[56:59]
    buffer_load_dwordx4 v[184:187], v243, s[48:51], s78 offen
    v_perm_b32 v225, v140, v136, s80
    v_mfma_f32_16x16x32_bf16 v[88:91], v[232:235], a[8:11], v[88:91]
    v_perm_b32 v226, v148, v144, s80
    v_mfma_f32_16x16x32_bf16 v[120:123], v[232:235], a[12:15], v[120:123]
    v_perm_b32 v227, v156, v152, s80
    v_mfma_f32_16x16x32_bf16 v[28:31], v[236:239], a[0:3], v[28:31]
    v_perm_b32 v228, v132, v128, s81
    v_mfma_f32_16x16x32_bf16 v[60:63], v[236:239], a[4:7], v[60:63]
    buffer_load_dwordx4 v[188:191], v243, s[48:51], s79 offen
    v_perm_b32 v229, v140, v136, s81
    v_mfma_f32_16x16x32_bf16 v[92:95], v[236:239], a[8:11], v[92:95]
    v_perm_b32 v230, v148, v144, s81
    v_mfma_f32_16x16x32_bf16 v[124:127], v[236:239], a[12:15], v[124:127]
    v_perm_b32 v231, v156, v152, s81
    s_cmp_eq_u32 s85, 2
    s_cbranch_scc0 L_b6
    s_barrier
    s_cmp_eq_u32 s68, 0
    s_cbranch_scc0 L_b6_n
    v_accvgpr_read_b32 v232, a88
    v_accvgpr_read_b32 v233, a89
    v_accvgpr_read_b32 v234, a90
    v_accvgpr_read_b32 v235, a91
    v_readfirstlane_b32 s70, v232
L_b6_l:
    s_nop 0
    s_add_u32 s70, s70, 1
    s_cbranch_scc1 L_b6_l
    v_cmp_eq_u32 vcc, s70, v232
    v_cmp_eq_u32 s[94:95], s70, v233
    v_cmp_eq_u32 s[96:97], s70, v234
    s_or_b64 s[94:95], s[94:95], vcc
    v_cmp_eq_u32 vcc, s70, v235
    s_or_b64 s[94:95], s[94:95], s[96:97]
    s_or_b64 s[94:95], s[94:95], vcc
    s_cbranch_scc1 L_b6_l
    v_mov_b32 v236, s70
    s_mov_b64 exec, 1
    buffer_store_dword v236, off, s[28:31], s3 sc1
    s_mov_b64 exec, -1
L_b6_n:
    s_add_u32 m0, s88, 0
    s_nop 0
    buffer_load_dwordx4 v249, s[40:43], 0 offen offset:0 nt lds
    buffer_load_dwordx4 v249, s[40:43], 0 offen offset:1024 nt lds
    s_add_u32 m0, s88, 128
    s_nop 0
    buffer_load_dwordx4 v249, s[40:43], 0 offen offset:2048 nt lds
    buffer_load_dwordx4 v249, s[40:43], 0 offen offset:3072 nt lds
    s_add_u32 m0, s88, 4352
    s_nop 0
    buffer_load_dwordx4 v249, s[40:43], s86 offen offset:0 nt lds
    buffer_load_dwordx4 v249, s[40:43], s86 offen offset:1024 nt lds
    s_add_u32 m0, s88, 4480
    s_nop 0
    buffer_load_dwordx4 v249, s[40:43], s86 offen offset:2048 nt lds
    buffer_load_dwordx4 v249, s[40:43], s86 offen offset:3072 nt lds
L_b6:
    s_cmp_eq_u32 s85, 2
    s_cbranch_scc0 L_b7
    s_barrier
    s_add_u32 m0, s88, 8704
    s_nop 0
    buffer_load_dwordx4 v249, s[40:43], s73 offen offset:0 nt lds
    buffer_load_dwordx4 v249, s[40:43], s73 offen offset:1024 nt lds
    s_add_u32 m0, s88, 8832
    s_nop 0
    buffer_load_dwordx4 v249, s[40:43], s73 offen offset:2048 nt lds
    buffer_load_dwordx4 v249, s[40:43], s73 offen offset:3072 nt lds
    s_add_u32 m0, s88, 13056
    s_nop 0
    buffer_load_dwordx4 v249, s[40:43], s87 offen offset:0 nt lds
    buffer_load_dwordx4 v249, s[40:43], s87 offen offset:1024 nt lds
    s_add_u32 m0, s88, 13184
    s_nop 0
    buffer_load_dwordx4 v249, s[40:43], s87 offen offset:2048 nt lds
    buffer_load_dwordx4 v249, s[40:43], s87 offen offset:3072 nt lds
L_b7:
    s_cmp_eq_u32 s85, 2
    s_cbranch_scc0 L_b8
    s_barrier
    buffer_load_dwordx4 a[32:35], v250, s[44:47], 0 offen offset:0 nt
    buffer_load_dwordx4 a[36:39], v250, s[44:47], 0 offen offset:1024 nt
    buffer_load_dwordx4 a[40:43], v250, s[44:47], 0 offen offset:2048 nt
    buffer_load_dwordx4 a[44:47], v250, s[44:47], 0 offen offset:3072 nt
    buffer_load_dwordx4 a[48:51], v250, s[44:47], s86 offen offset:0 nt
    buffer_load_dwordx4 a[52:55], v250, s[44:47], s86 offen offset:1024 nt
    buffer_load_dwordx4 a[56:59], v250, s[44:47], s86 offen offset:2048 nt
    buffer_load_dwordx4 a[60:63], v250, s[44:47], s86 offen offset:3072 nt
L_b8:
    s_waitcnt lgkmcnt(0)
    v_mfma_f32_16x16x32_bf16 v[0:3], v[224:227], a[16:19], v[0:3]
    v_perm_b32 v232, v133, v129, s80
    v_add_u32 v248, s84, v246
    v_mfma_f32_16x16x32_bf16 v[32:35], v[224:227], a[20:23], v[32:35]
    buffer_load_dwordx4 v[192:195], v244, s[48:51], 0 offen
    v_perm_b32 v233, v141, v137, s80
    v_mfma_f32_16x16x32_bf16 v[64:67], v[224:227], a[24:27], v[64:67]
    v_perm_b32 v234, v149, v145, s80
    v_mfma_f32_16x16x32_bf16 v[96:99], v[224:227], a[28:31], v[96:99]
    ds_read_b128 a[0:3], v247 offset:0
    v_perm_b32 v235, v157, v153, s80
    v_mfma_f32_16x16x32_bf16 v[4:7], v[228:231], a[16:19], v[4:7]
    v_perm_b32 v236, v133, v129, s81
    v_mfma_f32_16x16x32_bf16 v[36:39], v[228:231], a[20:23], v[36:39]
    buffer_load_dwordx4 v[196:199], v244, s[48:51], s73 offen
    v_perm_b32 v237, v141, v137, s81
    v_mfma_f32_16x16x32_bf16 v[68:71], v[228:231], a[24:27], v[68:71]
    v_perm_b32 v238, v149, v145, s81
    v_mfma_f32_16x16x32_bf16 v[100:103], v[228:231], a[28:31], v[100:103]
    ds_read_b128 a[4:7], v247 offset:2048
    v_perm_b32 v239, v157, v153, s81
    v_mfma_f32_16x16x32_bf16 v[8:11], v[232:235], a[16:19], v[8:11]
    v_perm_b32 v224, v134, v130, s80
    v_mfma_f32_16x16x32_bf16 v[40:43], v[232:235], a[20:23], v[40:43]
    buffer_load_dwordx4 v[200:203], v244, s[48:51], s74 offen
    v_perm_b32 v225, v142, v138, s80
    v_mfma_f32_16x16x32_bf16 v[72:75], v[232:235], a[24:27], v[72:75]
    v_perm_b32 v226, v150, v146, s80
    v_mfma_f32_16x16x32_bf16 v[104:107], v[232:235], a[28:31], v[104:107]
    ds_read_b128 a[8:11], v247 offset:4096
    v_perm_b32 v227, v158, v154, s80
    v_mfma_f32_16x16x32_bf16 v[12:15], v[236:239], a[16:19], v[12:15]
    v_perm_b32 v228, v134, v130, s81
    v_mfma_f32_16x16x32_bf16 v[44:47], v[236:239], a[20:23], v[44:47]
    buffer_load_dwordx4 v[204:207], v244, s[48:51], s75 offen
    v_perm_b32 v229, v142, v138, s81
    v_mfma_f32_16x16x32_bf16 v[76:79], v[236:239], a[24:27], v[76:79]
    v_perm_b32 v230, v150, v146, s81
    v_mfma_f32_16x16x32_bf16 v[108:111], v[236:239], a[28:31], v[108:111]
    ds_read_b128 a[12:15], v247 offset:6144
    v_perm_b32 v231, v158, v154, s81
    v_mfma_f32_16x16x32_bf16 v[16:19], v[224:227], a[16:19], v[16:19]
    v_perm_b32 v232, v135, v131, s80
    v_mfma_f32_16x16x32_bf16 v[48:51], v[224:227], a[20:23], v[48:51]
    buffer_load_dwordx4 v[208:211], v244, s[48:51], s76 offen
    v_perm_b32 v233, v143, v139, s80
    v_mfma_f32_16x16x32_bf16 v[80:83], v[224:227], a[24:27], v[80:83]
    v_perm_b32 v234, v151, v147, s80
    v_mfma_f32_16x16x32_bf16 v[112:115], v[224:227], a[28:31], v[112:115]
    v_perm_b32 v235, v159, v155, s80
    v_mfma_f32_16x16x32_bf16 v[20:23], v[228:231], a[16:19], v[20:23]
    v_perm_b32 v236, v135, v131, s81
    v_mfma_f32_16x16x32_bf16 v[52:55], v[228:231], a[20:23], v[52:55]
    buffer_load_dwordx4 v[212:215], v244, s[48:51], s77 offen
    v_perm_b32 v237, v143, v139, s81
    v_mfma_f32_16x16x32_bf16 v[84:87], v[228:231], a[24:27], v[84:87]
    v_perm_b32 v238, v151, v147, s81
    v_mfma_f32_16x16x32_bf16 v[116:119], v[228:231], a[28:31], v[116:119]
    v_perm_b32 v239, v159, v155, s81
    v_mfma_f32_16x16x32_bf16 v[24:27], v[232:235], a[16:19], v[24:27]
    s_waitcnt vmcnt(6)
    v_perm_b32 v224, v164, v160, s80
    v_mfma_f32_16x16x32_bf16 v[56:59], v[232:235], a[20:23], v[56:59]
    buffer_load_dwordx4 v[216:219], v244, s[48:51], s78 offen
    v_perm_b32 v225, v172, v168, s80
    v_mfma_f32_16x16x32_bf16 v[88:91], v[232:235], a[24:27], v[88:91]
    v_perm_b32 v226, v180, v176, s80
    v_mfma_f32_16x16x32_bf16 v[120:123], v[232:235], a[28:31], v[120:123]
    v_perm_b32 v227, v188, v184, s80
    v_mfma_f32_16x16x32_bf16 v[28:31], v[236:239], a[16:19], v[28:31]
    v_perm_b32 v228, v164, v160, s81
    v_mfma_f32_16x16x32_bf16 v[60:63], v[236:239], a[20:23], v[60:63]
    buffer_load_dwordx4 v[220:223], v244, s[48:51], s79 offen
    v_perm_b32 v229, v172, v168, s81
    v_mfma_f32_16x16x32_bf16 v[92:95], v[236:239], a[24:27], v[92:95]
    v_perm_b32 v230, v180, v176, s81
    v_mfma_f32_16x16x32_bf16 v[124:127], v[236:239], a[28:31], v[124:127]
    v_perm_b32 v231, v188, v184, s81
    s_waitcnt lgkmcnt(0)
    v_mfma_f32_16x16x32_bf16 v[0:3], v[224:227], a[0:3], v[0:3]
    s_lshr_b64 s[6:7], s[6:7], 4
    s_and_b32 s82, s6, 15
    s_lshl_b32 s83, s82, 19
    v_perm_b32 v232, v165, v161, s80
    v_add_u32 v243, s83, v241
    v_mfma_f32_16x16x32_bf16 v[32:35], v[224:227], a[4:7], v[32:35]
    buffer_load_dwordx4 v[128:131], v243, s[48:51], 0 offen
    v_perm_b32 v233, v173, v169, s80
    v_mfma_f32_16x16x32_bf16 v[64:67], v[224:227], a[8:11], v[64:67]
    v_perm_b32 v234, v181, v177, s80
    v_mfma_f32_16x16x32_bf16 v[96:99], v[224:227], a[12:15], v[96:99]
    ds_read_b128 a[16:19], v248 offset:0
    v_perm_b32 v235, v189, v185, s80
    v_mfma_f32_16x16x32_bf16 v[4:7], v[228:231], a[0:3], v[4:7]
    v_perm_b32 v236, v165, v161, s81
    v_add_u32 v244, s83, v242
    v_mfma_f32_16x16x32_bf16 v[36:39], v[228:231], a[4:7], v[36:39]
    buffer_load_dwordx4 v[132:135], v243, s[48:51], s73 offen
    v_perm_b32 v237, v173, v169, s81
    v_mfma_f32_16x16x32_bf16 v[68:71], v[228:231], a[8:11], v[68:71]
    s_lshl_b32 s84, s82, 13
    v_perm_b32 v238, v181, v177, s81
    v_mfma_f32_16x16x32_bf16 v[100:103], v[228:231], a[12:15], v[100:103]
    ds_read_b128 a[20:23], v248 offset:2048
    v_perm_b32 v239, v189, v185, s81
    v_mfma_f32_16x16x32_bf16 v[8:11], v[232:235], a[0:3], v[8:11]
    v_perm_b32 v224, v166, v162, s80
    v_add_u32 v247, s84, v245
    v_mfma_f32_16x16x32_bf16 v[40:43], v[232:235], a[4:7], v[40:43]
    buffer_load_dwordx4 v[136:139], v243, s[48:51], s74 offen
    v_perm_b32 v225, v174, v170, s80
    v_mfma_f32_16x16x32_bf16 v[72:75], v[232:235], a[8:11], v[72:75]
    v_perm_b32 v226, v182, v178, s80
    v_mfma_f32_16x16x32_bf16 v[104:107], v[232:235], a[12:15], v[104:107]
    ds_read_b128 a[24:27], v248 offset:4096
    v_perm_b32 v227, v190, v186, s80
    v_mfma_f32_16x16x32_bf16 v[12:15], v[236:239], a[0:3], v[12:15]
    v_perm_b32 v228, v166, v162, s81
    v_mfma_f32_16x16x32_bf16 v[44:47], v[236:239], a[4:7], v[44:47]
    buffer_load_dwordx4 v[140:143], v243, s[48:51], s75 offen
    v_perm_b32 v229, v174, v170, s81
    v_mfma_f32_16x16x32_bf16 v[76:79], v[236:239], a[8:11], v[76:79]
    v_perm_b32 v230, v182, v178, s81
    v_mfma_f32_16x16x32_bf16 v[108:111], v[236:239], a[12:15], v[108:111]
    ds_read_b128 a[28:31], v248 offset:6144
    v_perm_b32 v231, v190, v186, s81
    v_mfma_f32_16x16x32_bf16 v[16:19], v[224:227], a[0:3], v[16:19]
    v_perm_b32 v232, v167, v163, s80
    v_mfma_f32_16x16x32_bf16 v[48:51], v[224:227], a[4:7], v[48:51]
    buffer_load_dwordx4 v[144:147], v243, s[48:51], s76 offen
    v_perm_b32 v233, v175, v171, s80
    v_mfma_f32_16x16x32_bf16 v[80:83], v[224:227], a[8:11], v[80:83]
    v_perm_b32 v234, v183, v179, s80
    v_mfma_f32_16x16x32_bf16 v[112:115], v[224:227], a[12:15], v[112:115]
    v_perm_b32 v235, v191, v187, s80
    v_mfma_f32_16x16x32_bf16 v[20:23], v[228:231], a[0:3], v[20:23]
    v_perm_b32 v236, v167, v163, s81
    v_mfma_f32_16x16x32_bf16 v[52:55], v[228:231], a[4:7], v[52:55]
    buffer_load_dwordx4 v[148:151], v243, s[48:51], s77 offen
    v_perm_b32 v237, v175, v171, s81
    v_mfma_f32_16x16x32_bf16 v[84:87], v[228:231], a[8:11], v[84:87]
    v_perm_b32 v238, v183, v179, s81
    v_mfma_f32_16x16x32_bf16 v[116:119], v[228:231], a[12:15], v[116:119]
    v_perm_b32 v239, v191, v187, s81
    v_mfma_f32_16x16x32_bf16 v[24:27], v[232:235], a[0:3], v[24:27]
    s_waitcnt vmcnt(6)
    v_perm_b32 v224, v196, v192, s80
    v_mfma_f32_16x16x32_bf16 v[56:59], v[232:235], a[4:7], v[56:59]
    buffer_load_dwordx4 v[152:155], v243, s[48:51], s78 offen
    v_perm_b32 v225, v204, v200, s80
    v_mfma_f32_16x16x32_bf16 v[88:91], v[232:235], a[8:11], v[88:91]
    v_perm_b32 v226, v212, v208, s80
    v_mfma_f32_16x16x32_bf16 v[120:123], v[232:235], a[12:15], v[120:123]
    v_perm_b32 v227, v220, v216, s80
    v_mfma_f32_16x16x32_bf16 v[28:31], v[236:239], a[0:3], v[28:31]
    v_perm_b32 v228, v196, v192, s81
    v_mfma_f32_16x16x32_bf16 v[60:63], v[236:239], a[4:7], v[60:63]
    buffer_load_dwordx4 v[156:159], v243, s[48:51], s79 offen
    v_perm_b32 v229, v204, v200, s81
    v_mfma_f32_16x16x32_bf16 v[92:95], v[236:239], a[8:11], v[92:95]
    v_perm_b32 v230, v212, v208, s81
    v_mfma_f32_16x16x32_bf16 v[124:127], v[236:239], a[12:15], v[124:127]
    v_perm_b32 v231, v220, v216, s81
    s_cmp_eq_u32 s85, 3
    s_cbranch_scc0 L_b9
    s_barrier
    s_cmp_eq_u32 s68, 0
    s_cbranch_scc0 L_b9_n
    v_accvgpr_read_b32 v232, a88
    v_accvgpr_read_b32 v233, a89
    v_accvgpr_read_b32 v234, a90
    v_accvgpr_read_b32 v235, a91
    v_readfirstlane_b32 s70, v232
L_b9_l:
    s_nop 0
    s_add_u32 s70, s70, 1
    s_cbranch_scc1 L_b9_l
    v_cmp_eq_u32 vcc, s70, v232
    v_cmp_eq_u32 s[94:95], s70, v233
    v_cmp_eq_u32 s[96:97], s70, v234
    s_or_b64 s[94:95], s[94:95], vcc
    v_cmp_eq_u32 vcc, s70, v235
    s_or_b64 s[94:95], s[94:95], s[96:97]
    s_or_b64 s[94:95], s[94:95], vcc
    s_cbranch_scc1 L_b9_l
    v_mov_b32 v236, s70
    s_mov_b64 exec, 1
    buffer_store_dword v236, off, s[28:31], s3 sc1
    s_mov_b64 exec, -1
L_b9_n:
    s_add_u32 m0, s88, 0
    s_nop 0
    buffer_load_dwordx4 v249, s[40:43], 0 offen offset:0 nt lds
    buffer_load_dwordx4 v249, s[40:43], 0 offen offset:1024 nt lds
    s_add_u32 m0, s88, 128
    s_nop 0
    buffer_load_dwordx4 v249, s[40:43], 0 offen offset:2048 nt lds
    buffer_load_dwordx4 v249, s[40:43], 0 offen offset:3072 nt lds
    s_add_u32 m0, s88, 4352
    s_nop 0
    buffer_load_dwordx4 v249, s[40:43], s86 offen offset:0 nt lds
    buffer_load_dwordx4 v249, s[40:43], s86 offen offset:1024 nt lds
    s_add_u32 m0, s88, 4480
    s_nop 0
    buffer_load_dwordx4 v249, s[40:43], s86 offen offset:2048 nt lds
    buffer_load_dwordx4 v249, s[40:43], s86 offen offset:3072 nt lds
L_b9:
    s_cmp_eq_u32 s85, 3
    s_cbranch_scc0 L_b10
    s_barrier
    s_add_u32 m0, s88, 8704
    s_nop 0
    buffer_load_dwordx4 v249, s[40:43], s73 offen offset:0 nt lds
    buffer_load_dwordx4 v249, s[40:43], s73 offen offset:1024 nt lds
    s_add_u32 m0, s88, 8832
    s_nop 0
    buffer_load_dwordx4 v249, s[40:43], s73 offen offset:2048 nt lds
    buffer_load_dwordx4 v249, s[40:43], s73 offen offset:3072 nt lds
    s_add_u32 m0, s88, 13056
    s_nop 0
    buffer_load_dwordx4 v249, s[40:43], s87 offen offset:0 nt lds
    buffer_load_dwordx4 v249, s[40:43], s87 offen offset:1024 nt lds
    s_add_u32 m0, s88, 13184
    s_nop 0
    buffer_load_dwordx4 v249, s[40:43], s87 offen offset:2048 nt lds
    buffer_load_dwordx4 v249, s[40:43], s87 offen offset:3072 nt lds
L_b10:
    s_cmp_eq_u32 s85, 3
    s_cbranch_scc0 L_b11
    s_barrier
    buffer_load_dwordx4 a[32:35], v250, s[44:47], 0 offen offset:0 nt
    buffer_load_dwordx4 a[36:39], v250, s[44:47], 0 offen offset:1024 nt
    buffer_load_dwordx4 a[40:43], v250, s[44:47], 0 offen offset:2048 nt
    buffer_load_dwordx4 a[44:47], v250, s[44:47], 0 offen offset:3072 nt
    buffer_load_dwordx4 a[48:51], v250, s[44:47], s86 offen offset:0 nt
    buffer_load_dwordx4 a[52:55], v250, s[44:47], s86 offen offset:1024 nt
    buffer_load_dwordx4 a[56:59], v250, s[44:47], s86 offen offset:2048 nt
    buffer_load_dwordx4 a[60:63], v250, s[44:47], s86 offen offset:3072 nt
L_b11:
    s_waitcnt lgkmcnt(0)
    v_mfma_f32_16x16x32_bf16 v[0:3], v[224:227], a[16:19], v[0:3]
    v_perm_b32 v232, v197, v193, s80
    v_add_u32 v248, s84, v246
    v_mfma_f32_16x16x32_bf16 v[32:35], v[224:227], a[20:23], v[32:35]
    buffer_load_dwordx4 v[160:163], v244, s[48:51], 0 offen
    v_perm_b32 v233, v205, v201, s80
    v_mfma_f32_16x16x32_bf16 v[64:67], v[224:227], a[24:27], v[64:67]
    v_perm_b32 v234, v213, v209, s80
    v_mfma_f32_16x16x32_bf16 v[96:99], v[224:227], a[28:31], v[96:99]
    ds_read_b128 a[0:3], v247 offset:0
    v_perm_b32 v235, v221, v217, s80
    v_mfma_f32_16x16x32_bf16 v[4:7], v[228:231], a[16:19], v[4:7]
    v_perm_b32 v236, v197, v193, s81
    v_mfma_f32_16x16x32_bf16 v[36:39], v[228:231], a[20:23], v[36:39]
    buffer_load_dwordx4 v[164:167], v244, s[48:51], s73 offen
    v_perm_b32 v237, v205, v201, s81
    v_mfma_f32_16x16x32_bf16 v[68:71], v[228:231], a[24:27], v[68:71]
    v_perm_b32 v238, v213, v209, s81
    v_mfma_f32_16x16x32_bf16 v[100:103], v[228:231], a[28:31], v[100:103]
    ds_read_b128 a[4:7], v247 offset:2048
    v_perm_b32 v239, v221, v217, s81
    v_mfma_f32_16x16x32_bf16 v[8:11], v[232:235], a[16:19], v[8:11]
    v_perm_b32 v224, v198, v194, s80
    v_mfma_f32_16x16x32_bf16 v[40:43], v[232:235], a[20:23], v[40:43]
    buffer_load_dwordx4 v[168:171], v244, s[48:51], s74 offen
    v_perm_b32 v225, v206, v202, s80
    v_mfma_f32_16x16x32_bf16 v[72:75], v[232:235], a[24:27], v[72:75]
    v_perm_b32 v226, v214, v210, s80
    v_mfma_f32_16x16x32_bf16 v[104:107], v[232:235], a[28:31], v[104:107]
    ds_read_b128 a[8:11], v247 offset:4096
    v_perm_b32 v227, v222, v218, s80
    v_mfma_f32_16x16x32_bf16 v[12:15], v[236:239], a[16:19], v[12:15]
    v_perm_b32 v228, v198, v194, s81
    v_mfma_f32_16x16x32_bf16 v[44:47], v[236:239], a[20:23], v[44:47]
    buffer_load_dwordx4 v[172:175], v244, s[48:51], s75 offen
    v_perm_b32 v229, v206, v202, s81
    v_mfma_f32_16x16x32_bf16 v[76:79], v[236:239], a[24:27], v[76:79]
    v_perm_b32 v230, v214, v210, s81
    v_mfma_f32_16x16x32_bf16 v[108:111], v[236:239], a[28:31], v[108:111]
    ds_read_b128 a[12:15], v247 offset:6144
    v_perm_b32 v231, v222, v218, s81
    v_mfma_f32_16x16x32_bf16 v[16:19], v[224:227], a[16:19], v[16:19]
    v_perm_b32 v232, v199, v195, s80
    v_mfma_f32_16x16x32_bf16 v[48:51], v[224:227], a[20:23], v[48:51]
    buffer_load_dwordx4 v[176:179], v244, s[48:51], s76 offen
    v_perm_b32 v233, v207, v203, s80
    v_mfma_f32_16x16x32_bf16 v[80:83], v[224:227], a[24:27], v[80:83]
    v_perm_b32 v234, v215, v211, s80
    v_mfma_f32_16x16x32_bf16 v[112:115], v[224:227], a[28:31], v[112:115]
    v_perm_b32 v235, v223, v219, s80
    v_mfma_f32_16x16x32_bf16 v[20:23], v[228:231], a[16:19], v[20:23]
    v_perm_b32 v236, v199, v195, s81
    v_mfma_f32_16x16x32_bf16 v[52:55], v[228:231], a[20:23], v[52:55]
    buffer_load_dwordx4 v[180:183], v244, s[48:51], s77 offen
    v_perm_b32 v237, v207, v203, s81
    v_mfma_f32_16x16x32_bf16 v[84:87], v[228:231], a[24:27], v[84:87]
    v_perm_b32 v238, v215, v211, s81
    v_mfma_f32_16x16x32_bf16 v[116:119], v[228:231], a[28:31], v[116:119]
    v_perm_b32 v239, v223, v219, s81
    v_mfma_f32_16x16x32_bf16 v[24:27], v[232:235], a[16:19], v[24:27]
    s_waitcnt vmcnt(6)
    v_perm_b32 v224, v132, v128, s80
    v_mfma_f32_16x16x32_bf16 v[56:59], v[232:235], a[20:23], v[56:59]
    buffer_load_dwordx4 v[184:187], v244, s[48:51], s78 offen
    v_perm_b32 v225, v140, v136, s80
    v_mfma_f32_16x16x32_bf16 v[88:91], v[232:235], a[24:27], v[88:91]
    v_perm_b32 v226, v148, v144, s80
    v_mfma_f32_16x16x32_bf16 v[120:123], v[232:235], a[28:31], v[120:123]
    v_perm_b32 v227, v156, v152, s80
    v_mfma_f32_16x16x32_bf16 v[28:31], v[236:239], a[16:19], v[28:31]
    v_perm_b32 v228, v132, v128, s81
    v_mfma_f32_16x16x32_bf16 v[60:63], v[236:239], a[20:23], v[60:63]
    buffer_load_dwordx4 v[188:191], v244, s[48:51], s79 offen
    v_perm_b32 v229, v140, v136, s81
    v_mfma_f32_16x16x32_bf16 v[92:95], v[236:239], a[24:27], v[92:95]
    v_perm_b32 v230, v148, v144, s81
    v_mfma_f32_16x16x32_bf16 v[124:127], v[236:239], a[28:31], v[124:127]
    v_perm_b32 v231, v156, v152, s81
    s_waitcnt lgkmcnt(0)
    v_mfma_f32_16x16x32_bf16 v[0:3], v[224:227], a[0:3], v[0:3]
    s_lshr_b64 s[6:7], s[6:7], 4
    s_and_b32 s82, s6, 15
    s_lshl_b32 s83, s82, 19
    v_perm_b32 v232, v133, v129, s80
    v_add_u32 v243, s83, v241
    v_mfma_f32_16x16x32_bf16 v[32:35], v[224:227], a[4:7], v[32:35]
    buffer_load_dwordx4 v[192:195], v243, s[48:51], 0 offen
    v_perm_b32 v233, v141, v137, s80
    v_mfma_f32_16x16x32_bf16 v[64:67], v[224:227], a[8:11], v[64:67]
    v_perm_b32 v234, v149, v145, s80
    v_mfma_f32_16x16x32_bf16 v[96:99], v[224:227], a[12:15], v[96:99]
    ds_read_b128 a[16:19], v248 offset:0
    v_perm_b32 v235, v157, v153, s80
    v_mfma_f32_16x16x32_bf16 v[4:7], v[228:231], a[0:3], v[4:7]
    v_perm_b32 v236, v133, v129, s81
    v_add_u32 v244, s83, v242
    v_mfma_f32_16x16x32_bf16 v[36:39], v[228:231], a[4:7], v[36:39]
    buffer_load_dwordx4 v[196:199], v243, s[48:51], s73 offen
    v_perm_b32 v237, v141, v137, s81
    v_mfma_f32_16x16x32_bf16 v[68:71], v[228:231], a[8:11], v[68:71]
    s_lshl_b32 s84, s82, 13
    v_perm_b32 v238, v149, v145, s81
    v_mfma_f32_16x16x32_bf16 v[100:103], v[228:231], a[12:15], v[100:103]
    ds_read_b128 a[20:23], v248 offset:2048
    v_perm_b32 v239, v157, v153, s81
    v_mfma_f32_16x16x32_bf16 v[8:11], v[232:235], a[0:3], v[8:11]
    v_perm_b32 v224, v134, v130, s80
    v_add_u32 v247, s84, v245
    v_mfma_f32_16x16x32_bf16 v[40:43], v[232:235], a[4:7], v[40:43]
    buffer_load_dwordx4 v[200:203], v243, s[48:51], s74 offen
    v_perm_b32 v225, v142, v138, s80
    v_mfma_f32_16x16x32_bf16 v[72:75], v[232:235], a[8:11], v[72:75]
    v_perm_b32 v226, v150, v146, s80
    v_mfma_f32_16x16x32_bf16 v[104:107], v[232:235], a[12:15], v[104:107]
    ds_read_b128 a[24:27], v248 offset:4096
    v_perm_b32 v227, v158, v154, s80
    v_mfma_f32_16x16x32_bf16 v[12:15], v[236:239], a[0:3], v[12:15]
    v_perm_b32 v228, v134, v130, s81
    v_mfma_f32_16x16x32_bf16 v[44:47], v[236:239], a[4:7], v[44:47]
    buffer_load_dwordx4 v[204:207], v243, s[48:51], s75 offen
    v_perm_b32 v229, v142, v138, s81
    v_mfma_f32_16x16x32_bf16 v[76:79], v[236:239], a[8:11], v[76:79]
    v_perm_b32 v230, v150, v146, s81
    v_mfma_f32_16x16x32_bf16 v[108:111], v[236:239], a[12:15], v[108:111]
    ds_read_b128 a[28:31], v248 offset:6144
    v_perm_b32 v231, v158, v154, s81
    v_mfma_f32_16x16x32_bf16 v[16:19], v[224:227], a[0:3], v[16:19]
    v_perm_b32 v232, v135, v131, s80
    v_mfma_f32_16x16x32_bf16 v[48:51], v[224:227], a[4:7], v[48:51]
    buffer_load_dwordx4 v[208:211], v243, s[48:51], s76 offen
    v_perm_b32 v233, v143, v139, s80
    v_mfma_f32_16x16x32_bf16 v[80:83], v[224:227], a[8:11], v[80:83]
    v_perm_b32 v234, v151, v147, s80
    v_mfma_f32_16x16x32_bf16 v[112:115], v[224:227], a[12:15], v[112:115]
    v_perm_b32 v235, v159, v155, s80
    v_mfma_f32_16x16x32_bf16 v[20:23], v[228:231], a[0:3], v[20:23]
    v_perm_b32 v236, v135, v131, s81
    v_mfma_f32_16x16x32_bf16 v[52:55], v[228:231], a[4:7], v[52:55]
    buffer_load_dwordx4 v[212:215], v243, s[48:51], s77 offen
    v_perm_b32 v237, v143, v139, s81
    v_mfma_f32_16x16x32_bf16 v[84:87], v[228:231], a[8:11], v[84:87]
    v_perm_b32 v238, v151, v147, s81
    v_mfma_f32_16x16x32_bf16 v[116:119], v[228:231], a[12:15], v[116:119]
    v_perm_b32 v239, v159, v155, s81
    v_mfma_f32_16x16x32_bf16 v[24:27], v[232:235], a[0:3], v[24:27]
    s_waitcnt vmcnt(6)
    v_perm_b32 v224, v164, v160, s80
    v_mfma_f32_16x16x32_bf16 v[56:59], v[232:235], a[4:7], v[56:59]
    buffer_load_dwordx4 v[216:219], v243, s[48:51], s78 offen
    v_perm_b32 v225, v172, v168, s80
    v_mfma_f32_16x16x32_bf16 v[88:91], v[232:235], a[8:11], v[88:91]
    v_perm_b32 v226, v180, v176, s80
    v_mfma_f32_16x16x32_bf16 v[120:123], v[232:235], a[12:15], v[120:123]
    v_perm_b32 v227, v188, v184, s80
    v_mfma_f32_16x16x32_bf16 v[28:31], v[236:239], a[0:3], v[28:31]
    v_perm_b32 v228, v164, v160, s81
    v_mfma_f32_16x16x32_bf16 v[60:63], v[236:239], a[4:7], v[60:63]
    buffer_load_dwordx4 v[220:223], v243, s[48:51], s79 offen
    v_perm_b32 v229, v172, v168, s81
    v_mfma_f32_16x16x32_bf16 v[92:95], v[236:239], a[8:11], v[92:95]
    v_perm_b32 v230, v180, v176, s81
    v_mfma_f32_16x16x32_bf16 v[124:127], v[236:239], a[12:15], v[124:127]
    v_perm_b32 v231, v188, v184, s81
    s_waitcnt lgkmcnt(0)
    v_mfma_f32_16x16x32_bf16 v[0:3], v[224:227], a[16:19], v[0:3]
    v_perm_b32 v232, v165, v161, s80
    v_add_u32 v248, s84, v246
    v_mfma_f32_16x16x32_bf16 v[32:35], v[224:227], a[20:23], v[32:35]
    buffer_load_dwordx4 v[128:131], v244, s[48:51], 0 offen
    v_perm_b32 v233, v173, v169, s80
    v_mfma_f32_16x16x32_bf16 v[64:67], v[224:227], a[24:27], v[64:67]
    v_perm_b32 v234, v181, v177, s80
    v_mfma_f32_16x16x32_bf16 v[96:99], v[224:227], a[28:31], v[96:99]
    ds_read_b128 a[0:3], v247 offset:0
    v_perm_b32 v235, v189, v185, s80
    v_mfma_f32_16x16x32_bf16 v[4:7], v[228:231], a[16:19], v[4:7]
    v_perm_b32 v236, v165, v161, s81
    v_mfma_f32_16x16x32_bf16 v[36:39], v[228:231], a[20:23], v[36:39]
    buffer_load_dwordx4 v[132:135], v244, s[48:51], s73 offen
    v_perm_b32 v237, v173, v169, s81
    v_mfma_f32_16x16x32_bf16 v[68:71], v[228:231], a[24:27], v[68:71]
    v_perm_b32 v238, v181, v177, s81
    v_mfma_f32_16x16x32_bf16 v[100:103], v[228:231], a[28:31], v[100:103]
    ds_read_b128 a[4:7], v247 offset:2048
    v_perm_b32 v239, v189, v185, s81
    v_mfma_f32_16x16x32_bf16 v[8:11], v[232:235], a[16:19], v[8:11]
    v_perm_b32 v224, v166, v162, s80
    v_mfma_f32_16x16x32_bf16 v[40:43], v[232:235], a[20:23], v[40:43]
    buffer_load_dwordx4 v[136:139], v244, s[48:51], s74 offen
    v_perm_b32 v225, v174, v170, s80
    v_mfma_f32_16x16x32_bf16 v[72:75], v[232:235], a[24:27], v[72:75]
    v_perm_b32 v226, v182, v178, s80
    v_mfma_f32_16x16x32_bf16 v[104:107], v[232:235], a[28:31], v[104:107]
    ds_read_b128 a[8:11], v247 offset:4096
    v_perm_b32 v227, v190, v186, s80
    v_mfma_f32_16x16x32_bf16 v[12:15], v[236:239], a[16:19], v[12:15]
    v_perm_b32 v228, v166, v162, s81
    v_mfma_f32_16x16x32_bf16 v[44:47], v[236:239], a[20:23], v[44:47]
    buffer_load_dwordx4 v[140:143], v244, s[48:51], s75 offen
    v_perm_b32 v229, v174, v170, s81
    v_mfma_f32_16x16x32_bf16 v[76:79], v[236:239], a[24:27], v[76:79]
    v_perm_b32 v230, v182, v178, s81
    v_mfma_f32_16x16x32_bf16 v[108:111], v[236:239], a[28:31], v[108:111]
    ds_read_b128 a[12:15], v247 offset:6144
    v_perm_b32 v231, v190, v186, s81
    v_mfma_f32_16x16x32_bf16 v[16:19], v[224:227], a[16:19], v[16:19]
    v_perm_b32 v232, v167, v163, s80
    v_mfma_f32_16x16x32_bf16 v[48:51], v[224:227], a[20:23], v[48:51]
    buffer_load_dwordx4 v[144:147], v244, s[48:51], s76 offen
    v_perm_b32 v233, v175, v171, s80
    v_mfma_f32_16x16x32_bf16 v[80:83], v[224:227], a[24:27], v[80:83]
    v_perm_b32 v234, v183, v179, s80
    v_mfma_f32_16x16x32_bf16 v[112:115], v[224:227], a[28:31], v[112:115]
    v_perm_b32 v235, v191, v187, s80
    v_mfma_f32_16x16x32_bf16 v[20:23], v[228:231], a[16:19], v[20:23]
    v_perm_b32 v236, v167, v163, s81
    v_mfma_f32_16x16x32_bf16 v[52:55], v[228:231], a[20:23], v[52:55]
    buffer_load_dwordx4 v[148:151], v244, s[48:51], s77 offen
    v_perm_b32 v237, v175, v171, s81
    v_mfma_f32_16x16x32_bf16 v[84:87], v[228:231], a[24:27], v[84:87]
    v_perm_b32 v238, v183, v179, s81
    v_mfma_f32_16x16x32_bf16 v[116:119], v[228:231], a[28:31], v[116:119]
    v_perm_b32 v239, v191, v187, s81
    v_mfma_f32_16x16x32_bf16 v[24:27], v[232:235], a[16:19], v[24:27]
    s_waitcnt vmcnt(6)
    v_perm_b32 v224, v196, v192, s80
    v_mfma_f32_16x16x32_bf16 v[56:59], v[232:235], a[20:23], v[56:59]
    buffer_load_dwordx4 v[152:155], v244, s[48:51], s78 offen
    v_perm_b32 v225, v204, v200, s80
    v_mfma_f32_16x16x32_bf16 v[88:91], v[232:235], a[24:27], v[88:91]
    v_perm_b32 v226, v212, v208, s80
    v_mfma_f32_16x16x32_bf16 v[120:123], v[232:235], a[28:31], v[120:123]
    v_perm_b32 v227, v220, v216, s80
    v_mfma_f32_16x16x32_bf16 v[28:31], v[236:239], a[16:19], v[28:31]
    v_perm_b32 v228, v196, v192, s81
    v_mfma_f32_16x16x32_bf16 v[60:63], v[236:239], a[20:23], v[60:63]
    buffer_load_dwordx4 v[156:159], v244, s[48:51], s79 offen
    v_perm_b32 v229, v204, v200, s81
    v_mfma_f32_16x16x32_bf16 v[92:95], v[236:239], a[24:27], v[92:95]
    v_perm_b32 v230, v212, v208, s81
    v_mfma_f32_16x16x32_bf16 v[124:127], v[236:239], a[28:31], v[124:127]
    v_perm_b32 v231, v220, v216, s81
    s_waitcnt lgkmcnt(0)
    v_mfma_f32_16x16x32_bf16 v[0:3], v[224:227], a[0:3], v[0:3]
    s_lshr_b64 s[6:7], s[6:7], 4
    s_and_b32 s82, s6, 15
    s_lshl_b32 s83, s82, 19
    ds_read_b128 a[96:99], v254 offset:0
    v_perm_b32 v232, v197, v193, s80
    v_add_u32 v243, s83, v241
    v_mfma_f32_16x16x32_bf16 v[32:35], v[224:227], a[4:7], v[32:35]
    buffer_load_dwordx4 v[160:163], v243, s[48:51], 0 offen
    v_perm_b32 v233, v205, v201, s80
    v_mfma_f32_16x16x32_bf16 v[64:67], v[224:227], a[8:11], v[64:67]
    ds_read_b128 a[112:115], v254 offset:4352
    v_perm_b32 v234, v213, v209, s80
    v_mfma_f32_16x16x32_bf16 v[96:99], v[224:227], a[12:15], v[96:99]
    ds_read_b128 a[16:19], v248 offset:0
    v_perm_b32 v235, v221, v217, s80
    v_mfma_f32_16x16x32_bf16 v[4:7], v[228:231], a[0:3], v[4:7]
    ds_read_b128 a[128:131], v254 offset:8704
    v_perm_b32 v236, v197, v193, s81
    v_add_u32 v244, s83, v242
    v_mfma_f32_16x16x32_bf16 v[36:39], v[228:231], a[4:7], v[36:39]
    buffer_load_dwordx4 v[164:167], v243, s[48:51], s73 offen
    v_perm_b32 v237, v205, v201, s81
    v_mfma_f32_16x16x32_bf16 v[68:71], v[228:231], a[8:11], v[68:71]
    s_lshl_b32 s84, s82, 13
    ds_read_b128 a[144:147], v254 offset:13056
    v_perm_b32 v238, v213, v209, s81
    v_mfma_f32_16x16x32_bf16 v[100:103], v[228:231], a[12:15], v[100:103]
    ds_read_b128 a[20:23], v248 offset:2048
    v_perm_b32 v239, v221, v217, s81
    v_xor_b32 v249, 16, v254
    v_mfma_f32_16x16x32_bf16 v[8:11], v[232:235], a[0:3], v[8:11]
    ds_read_b128 a[100:103], v249 offset:0
    v_perm_b32 v224, v198, v194, s80
    v_add_u32 v247, s84, v245
    v_mfma_f32_16x16x32_bf16 v[40:43], v[232:235], a[4:7], v[40:43]
    buffer_load_dwordx4 v[168:171], v243, s[48:51], s74 offen
    v_perm_b32 v225, v206, v202, s80
    v_mfma_f32_16x16x32_bf16 v[72:75], v[232:235], a[8:11], v[72:75]
    ds_read_b128 a[116:119], v249 offset:4352
    v_perm_b32 v226, v214, v210, s80
    v_mfma_f32_16x16x32_bf16 v[104:107], v[232:235], a[12:15], v[104:107]
    ds_read_b128 a[24:27], v248 offset:4096
    v_perm_b32 v227, v222, v218, s80
    v_mfma_f32_16x16x32_bf16 v[12:15], v[236:239], a[0:3], v[12:15]
    ds_read_b128 a[132:135], v249 offset:8704
    v_perm_b32 v228, v198, v194, s81
    v_mfma_f32_16x16x32_bf16 v[44:47], v[236:239], a[4:7], v[44:47]
    buffer_load_dwordx4 v[172:175], v243, s[48:51], s75 offen
    v_perm_b32 v229, v206, v202, s81
    v_mfma_f32_16x16x32_bf16 v[76:79], v[236:239], a[8:11], v[76:79]
    ds_read_b128 a[148:151], v249 offset:13056
    v_perm_b32 v230, v214, v210, s81
    v_mfma_f32_16x16x32_bf16 v[108:111], v[236:239], a[12:15], v[108:111]
    ds_read_b128 a[28:31], v248 offset:6144
    v_perm_b32 v231, v222, v218, s81
    v_xor_b32 v249, 32, v254
    v_mfma_f32_16x16x32_bf16 v[16:19], v[224:227], a[0:3], v[16:19]
    ds_read_b128 a[104:107], v249 offset:0
    v_perm_b32 v232, v199, v195, s80
    v_mfma_f32_16x16x32_bf16 v[48:51], v[224:227], a[4:7], v[48:51]
    buffer_load_dwordx4 v[176:179], v243, s[48:51], s76 offen
    v_perm_b32 v233, v207, v203, s80
    v_mfma_f32_16x16x32_bf16 v[80:83], v[224:227], a[8:11], v[80:83]
    ds_read_b128 a[120:123], v249 offset:4352
    v_perm_b32 v234, v215, v211, s80
    v_mfma_f32_16x16x32_bf16 v[112:115], v[224:227], a[12:15], v[112:115]
    v_perm_b32 v235, v223, v219, s80
    v_mfma_f32_16x16x32_bf16 v[20:23], v[228:231], a[0:3], v[20:23]
    ds_read_b128 a[136:139], v249 offset:8704
    v_perm_b32 v236, v199, v195, s81
    v_mfma_f32_16x16x32_bf16 v[52:55], v[228:231], a[4:7], v[52:55]
    buffer_load_dwordx4 v[180:183], v243, s[48:51], s77 offen
    v_perm_b32 v237, v207, v203, s81
    v_mfma_f32_16x16x32_bf16 v[84:87], v[228:231], a[8:11], v[84:87]
    ds_read_b128 a[152:155], v249 offset:13056
    v_perm_b32 v238, v215, v211, s81
    v_mfma_f32_16x16x32_bf16 v[116:119], v[228:231], a[12:15], v[116:119]
    v_perm_b32 v239, v223, v219, s81
    v_xor_b32 v249, 48, v254
    v_mfma_f32_16x16x32_bf16 v[24:27], v[232:235], a[0:3], v[24:27]
    s_waitcnt vmcnt(6)
    ds_read_b128 a[108:111], v249 offset:0
    v_perm_b32 v224, v132, v128, s80
    v_mfma_f32_16x16x32_bf16 v[56:59], v[232:235], a[4:7], v[56:59]
    buffer_load_dwordx4 v[184:187], v243, s[48:51], s78 offen
    v_perm_b32 v225, v140, v136, s80
    v_mfma_f32_16x16x32_bf16 v[88:91], v[232:235], a[8:11], v[88:91]
    ds_read_b128 a[124:127], v249 offset:4352
    v_perm_b32 v226, v148, v144, s80
    v_mfma_f32_16x16x32_bf16 v[120:123], v[232:235], a[12:15], v[120:123]
    v_perm_b32 v227, v156, v152, s80
    v_mfma_f32_16x16x32_bf16 v[28:31], v[236:239], a[0:3], v[28:31]
    ds_read_b128 a[140:143], v249 offset:8704
    v_perm_b32 v228, v132, v128, s81
    v_mfma_f32_16x16x32_bf16 v[60:63], v[236:239], a[4:7], v[60:63]
    buffer_load_dwordx4 v[188:191], v243, s[48:51], s79 offen
    v_perm_b32 v229, v140, v136, s81
    v_mfma_f32_16x16x32_bf16 v[92:95], v[236:239], a[8:11], v[92:95]
    ds_read_b128 a[156:159], v249 offset:13056
    v_perm_b32 v230, v148, v144, s81
    v_mfma_f32_16x16x32_bf16 v[124:127], v[236:239], a[12:15], v[124:127]
    v_perm_b32 v231, v156, v152, s81
    s_waitcnt lgkmcnt(8)
    v_mfma_f32_16x16x32_bf16 v[0:3], v[224:227], a[16:19], v[0:3]
    v_perm_b32 v232, v133, v129, s80
    v_add_u32 v248, s84, v246
    v_mfma_f32_16x16x32_bf16 v[32:35], v[224:227], a[20:23], v[32:35]
    buffer_load_dwordx4 v[192:195], v244, s[48:51], 0 offen
    v_perm_b32 v233, v141, v137, s80
    v_mfma_f32_16x16x32_bf16 v[64:67], v[224:227], a[24:27], v[64:67]
    v_perm_b32 v234, v149, v145, s80
    v_mfma_f32_16x16x32_bf16 v[96:99], v[224:227], a[28:31], v[96:99]
    ds_read_b128 a[0:3], v247 offset:0
    v_perm_b32 v235, v157, v153, s80
    v_mfma_f32_16x16x32_bf16 v[4:7], v[228:231], a[16:19], v[4:7]
    v_perm_b32 v236, v133, v129, s81
    v_mfma_f32_16x16x32_bf16 v[36:39], v[228:231], a[20:23], v[36:39]
    buffer_load_dwordx4 v[196:199], v244, s[48:51], s73 offen
    v_perm_b32 v237, v141, v137, s81
    v_mfma_f32_16x16x32_bf16 v[68:71], v[228:231], a[24:27], v[68:71]
    v_perm_b32 v238, v149, v145, s81
    v_mfma_f32_16x16x32_bf16 v[100:103], v[228:231], a[28:31], v[100:103]
    ds_read_b128 a[4:7], v247 offset:2048
    v_perm_b32 v239, v157, v153, s81
    v_mfma_f32_16x16x32_bf16 v[8:11], v[232:235], a[16:19], v[8:11]
    v_perm_b32 v224, v134, v130, s80
    v_mfma_f32_16x16x32_bf16 v[40:43], v[232:235], a[20:23], v[40:43]
    buffer_load_dwordx4 v[200:203], v244, s[48:51], s74 offen
    v_perm_b32 v225, v142, v138, s80
    v_mfma_f32_16x16x32_bf16 v[72:75], v[232:235], a[24:27], v[72:75]
    v_perm_b32 v226, v150, v146, s80
    v_mfma_f32_16x16x32_bf16 v[104:107], v[232:235], a[28:31], v[104:107]
    ds_read_b128 a[8:11], v247 offset:4096
    v_perm_b32 v227, v158, v154, s80
    v_mfma_f32_16x16x32_bf16 v[12:15], v[236:239], a[16:19], v[12:15]
    v_perm_b32 v228, v134, v130, s81
    v_mfma_f32_16x16x32_bf16 v[44:47], v[236:239], a[20:23], v[44:47]
    buffer_load_dwordx4 v[204:207], v244, s[48:51], s75 offen
    v_perm_b32 v229, v142, v138, s81
    v_mfma_f32_16x16x32_bf16 v[76:79], v[236:239], a[24:27], v[76:79]
    v_perm_b32 v230, v150, v146, s81
    v_mfma_f32_16x16x32_bf16 v[108:111], v[236:239], a[28:31], v[108:111]
    ds_read_b128 a[12:15], v247 offset:6144
    v_perm_b32 v231, v158, v154, s81
    v_mfma_f32_16x16x32_bf16 v[16:19], v[224:227], a[16:19], v[16:19]
    v_perm_b32 v232, v135, v131, s80
    v_mfma_f32_16x16x32_bf16 v[48:51], v[224:227], a[20:23], v[48:51]
    buffer_load_dwordx4 v[208:211], v244, s[48:51], s76 offen
    v_perm_b32 v233, v143, v139, s80
    v_mfma_f32_16x16x32_bf16 v[80:83], v[224:227], a[24:27], v[80:83]
    v_perm_b32 v234, v151, v147, s80
    v_mfma_f32_16x16x32_bf16 v[112:115], v[224:227], a[28:31], v[112:115]
    ds_read_b128 a[64:67], v248 offset:0
    v_perm_b32 v235, v159, v155, s80
    v_mfma_f32_16x16x32_bf16 v[20:23], v[228:231], a[16:19], v[20:23]
    v_perm_b32 v236, v135, v131, s81
    v_mfma_f32_16x16x32_bf16 v[52:55], v[228:231], a[20:23], v[52:55]
    buffer_load_dwordx4 v[212:215], v244, s[48:51], s77 offen
    v_perm_b32 v237, v143, v139, s81
    v_mfma_f32_16x16x32_bf16 v[84:87], v[228:231], a[24:27], v[84:87]
    v_perm_b32 v238, v151, v147, s81
    v_mfma_f32_16x16x32_bf16 v[116:119], v[228:231], a[28:31], v[116:119]
    ds_read_b128 a[68:71], v248 offset:2048
    v_perm_b32 v239, v159, v155, s81
    v_mfma_f32_16x16x32_bf16 v[24:27], v[232:235], a[16:19], v[24:27]
    s_waitcnt vmcnt(6)
    v_perm_b32 v224, v164, v160, s80
    v_mfma_f32_16x16x32_bf16 v[56:59], v[232:235], a[20:23], v[56:59]
    buffer_load_dwordx4 v[216:219], v244, s[48:51], s78 offen
    v_perm_b32 v225, v172, v168, s80
    v_mfma_f32_16x16x32_bf16 v[88:91], v[232:235], a[24:27], v[88:91]
    v_perm_b32 v226, v180, v176, s80
    v_mfma_f32_16x16x32_bf16 v[120:123], v[232:235], a[28:31], v[120:123]
    ds_read_b128 a[72:75], v248 offset:4096
    v_perm_b32 v227, v188, v184, s80
    v_mfma_f32_16x16x32_bf16 v[28:31], v[236:239], a[16:19], v[28:31]
    v_perm_b32 v228, v164, v160, s81
    v_mfma_f32_16x16x32_bf16 v[60:63], v[236:239], a[20:23], v[60:63]
    buffer_load_dwordx4 v[220:223], v244, s[48:51], s79 offen
    v_perm_b32 v229, v172, v168, s81
    v_mfma_f32_16x16x32_bf16 v[92:95], v[236:239], a[24:27], v[92:95]
    v_perm_b32 v230, v180, v176, s81
    v_mfma_f32_16x16x32_bf16 v[124:127], v[236:239], a[28:31], v[124:127]
    ds_read_b128 a[76:79], v248 offset:6144
    v_perm_b32 v231, v188, v184, s81
    s_waitcnt lgkmcnt(0)
    s_barrier
    s_lshl_b32 s75, s64, 11
    s_sub_u32 s75, 65536, s75
    s_lshl_b32 s69, s64, 14
    s_add_u32 m0, s69, 8192
    v_mfma_f32_16x16x32_bf16 v[0:3], v[224:227], a[0:3], v[0:3]
    v_lshrrev_b32 v128, 4, v240
    v_lshlrev_b32 v128, 5, v128
    v_mfma_f32_16x16x32_bf16 v[32:35], v[224:227], a[4:7], v[32:35]
    v_xor_b32 v130, v128, v250
    v_xor_b32 v131, 128, v130
    v_mfma_f32_16x16x32_bf16 v[64:67], v[224:227], a[8:11], v[64:67]
    buffer_load_dwordx4 v130, s[44:47], s73 offen offset:0 nt lds
    v_perm_b32 v232, v165, v161, s80
    v_mfma_f32_16x16x32_bf16 v[96:99], v[224:227], a[12:15], v[96:99]
    v_perm_b32 v233, v173, v169, s80
    v_perm_b32 v234, v181, v177, s80
    v_mfma_f32_16x16x32_bf16 v[4:7], v[228:231], a[0:3], v[4:7]
    v_perm_b32 v235, v189, v185, s80
    v_perm_b32 v236, v165, v161, s81
    v_mfma_f32_16x16x32_bf16 v[36:39], v[228:231], a[4:7], v[36:39]
    buffer_load_dwordx4 v131, s[44:47], s73 offen offset:1024 nt lds
    v_perm_b32 v237, v173, v169, s81
    v_mfma_f32_16x16x32_bf16 v[68:71], v[228:231], a[8:11], v[68:71]
    v_perm_b32 v238, v181, v177, s81
    v_perm_b32 v239, v189, v185, s81
    v_mfma_f32_16x16x32_bf16 v[100:103], v[228:231], a[12:15], v[100:103]
    v_perm_b32 v224, v166, v162, s80
    v_perm_b32 v225, v174, v170, s80
    v_mfma_f32_16x16x32_bf16 v[8:11], v[232:235], a[0:3], v[8:11]
    buffer_load_dwordx4 v130, s[44:47], s73 offen offset:2048 nt lds
    v_perm_b32 v226, v182, v178, s80
    v_mfma_f32_16x16x32_bf16 v[40:43], v[232:235], a[4:7], v[40:43]
    v_perm_b32 v227, v190, v186, s80
    v_perm_b32 v228, v166, v162, s81
    v_mfma_f32_16x16x32_bf16 v[72:75], v[232:235], a[8:11], v[72:75]
    v_perm_b32 v229, v174, v170, s81
    v_perm_b32 v230, v182, v178, s81
    v_mfma_f32_16x16x32_bf16 v[104:107], v[232:235], a[12:15], v[104:107]
    buffer_load_dwordx4 v131, s[44:47], s73 offen offset:3072 nt lds
    s_add_u32 m0, s69, 12288
    v_perm_b32 v231, v190, v186, s81
    v_mfma_f32_16x16x32_bf16 v[12:15], v[236:239], a[0:3], v[12:15]
    v_perm_b32 v232, v167, v163, s80
    v_perm_b32 v233, v175, v171, s80
    v_mfma_f32_16x16x32_bf16 v[44:47], v[236:239], a[4:7], v[44:47]
    v_perm_b32 v234, v183, v179, s80
    v_perm_b32 v235, v191, v187, s80
    v_mfma_f32_16x16x32_bf16 v[76:79], v[236:239], a[8:11], v[76:79]
    buffer_load_dwordx4 v130, s[44:47], s87 offen offset:0 nt lds
    v_lshrrev_b32 v128, 4, v240
    v_mfma_f32_16x16x32_bf16 v[108:111], v[236:239], a[12:15], v[108:111]
    v_perm_b32 v236, v167, v163, s81
    v_perm_b32 v237, v175, v171, s81
    v_mfma_f32_16x16x32_bf16 v[16:19], v[224:227], a[0:3], v[16:19]
    v_perm_b32 v238, v183, v179, s81
    v_perm_b32 v239, v191, v187, s81
    v_mfma_f32_16x16x32_bf16 v[48:51], v[224:227], a[4:7], v[48:51]
    buffer_load_dwordx4 v131, s[44:47], s87 offen offset:1024 nt lds
    v_bfe_u32 v129, v240, 1, 3
    v_mfma_f32_16x16x32_bf16 v[80:83], v[224:227], a[8:11], v[80:83]
    v_xor_b32 v129, v129, v128
    v_lshlrev_b32 v129, 5, v129
    v_mfma_f32_16x16x32_bf16 v[112:115], v[224:227], a[12:15], v[112:115]
    s_waitcnt vmcnt(12)
    v_perm_b32 v224, v196, v192, s80
    s_waitcnt vmcnt(10)
    v_perm_b32 v225, v204, v200, s80
    v_mfma_f32_16x16x32_bf16 v[20:23], v[228:231], a[0:3], v[20:23]
    buffer_load_dwordx4 v130, s[44:47], s87 offen offset:2048 nt lds
    s_waitcnt vmcnt(9)
    v_perm_b32 v226, v212, v208, s80
    v_mfma_f32_16x16x32_bf16 v[52:55], v[228:231], a[4:7], v[52:55]
    s_waitcnt vmcnt(7)
    v_perm_b32 v227, v220, v216, s80
    v_lshl_add_u32 v129, v128, 8, v129
    v_mfma_f32_16x16x32_bf16 v[84:87], v[228:231], a[8:11], v[84:87]
    v_and_b32 v128, 1, v240
    v_lshl_add_u32 v129, v128, 4, v129
    v_mfma_f32_16x16x32_bf16 v[116:119], v[228:231], a[12:15], v[116:119]
    buffer_load_dwordx4 v131, s[44:47], s87 offen offset:3072 nt lds
    v_perm_b32 v228, v196, v192, s81
    v_mfma_f32_16x16x32_bf16 v[24:27], v[232:235], a[0:3], v[24:27]
    v_perm_b32 v229, v204, v200, s81
    v_perm_b32 v230, v212, v208, s81
    v_mfma_f32_16x16x32_bf16 v[56:59], v[232:235], a[4:7], v[56:59]
    v_perm_b32 v231, v220, v216, s81
    v_lshrrev_b32 v128, 2, v240
    v_mfma_f32_16x16x32_bf16 v[88:91], v[232:235], a[8:11], v[88:91]
    v_perm_b32 v160, v197, v193, s80
    v_perm_b32 v161, v205, v201, s80
    v_mfma_f32_16x16x32_bf16 v[120:123], v[232:235], a[12:15], v[120:123]
    v_perm_b32 v162, v213, v209, s80
    v_perm_b32 v163, v221, v217, s80
    v_mfma_f32_16x16x32_bf16 v[28:31], v[236:239], a[0:3], v[28:31]
    v_perm_b32 v164, v197, v193, s81
    v_perm_b32 v165, v205, v201, s81
    v_mfma_f32_16x16x32_bf16 v[60:63], v[236:239], a[4:7], v[60:63]
    v_perm_b32 v166, v213, v209, s81
    v_perm_b32 v167, v221, v217, s81
    v_mfma_f32_16x16x32_bf16 v[92:95], v[236:239], a[8:11], v[92:95]
    v_perm_b32 v168, v198, v194, s80
    v_perm_b32 v169, v206, v202, s80
    v_mfma_f32_16x16x32_bf16 v[124:127], v[236:239], a[12:15], v[124:127]
    v_perm_b32 v170, v214, v210, s80
    v_perm_b32 v171, v222, v218, s80
    v_mfma_f32_16x16x32_bf16 v[0:3], v[224:227], a[64:67], v[0:3]
    v_perm_b32 v172, v198, v194, s81
    v_perm_b32 v173, v206, v202, s81
    v_mfma_f32_16x16x32_bf16 v[4:7], v[228:231], a[64:67], v[4:7]
    v_perm_b32 v174, v214, v210, s81
    v_perm_b32 v175, v222, v218, s81
    v_mfma_f32_16x16x32_bf16 v[8:11], v[160:163], a[64:67], v[8:11]
    v_perm_b32 v176, v199, v195, s80
    v_perm_b32 v177, v207, v203, s80
    v_mfma_f32_16x16x32_bf16 v[12:15], v[164:167], a[64:67], v[12:15]
    v_perm_b32 v178, v215, v211, s80
    v_perm_b32 v179, v223, v219, s80
    v_mfma_f32_16x16x32_bf16 v[16:19], v[168:171], a[64:67], v[16:19]
    v_perm_b32 v180, v199, v195, s81
    v_perm_b32 v181, v207, v203, s81
    v_mfma_f32_16x16x32_bf16 v[20:23], v[172:175], a[64:67], v[20:23]
    v_perm_b32 v182, v215, v211, s81
    v_perm_b32 v183, v223, v219, s81
    v_mfma_f32_16x16x32_bf16 v[24:27], v[176:179], a[64:67], v[24:27]
    v_min_u32 v217, 7, v240
    v_mul_u32_u24 v217, 1152, v217
    v_mfma_f32_16x16x32_bf16 v[28:31], v[180:183], a[64:67], v[28:31]
    v_add_u32 v223, 1024, v252
    v_lshlrev_b32 v222, 4, v240
    v_mfma_f32_16x16x32_bf16 v[32:35], v[224:227], a[68:71], v[32:35]
    v_cvt_pk_bf16_f32 v130, v16, v20
    v_cvt_pk_bf16_f32 v132, v1, v5
    v_mfma_f32_16x16x32_bf16 v[36:39], v[228:231], a[68:71], v[36:39]
    v_cvt_pk_bf16_f32 v133, v9, v13
    v_cvt_pk_bf16_f32 v134, v17, v21
    v_mfma_f32_16x16x32_bf16 v[40:43], v[160:163], a[68:71], v[40:43]
    v_cvt_pk_bf16_f32 v131, v24, v28
    v_cvt_pk_bf16_f32 v135, v25, v29
    v_mfma_f32_16x16x32_bf16 v[44:47], v[164:167], a[68:71], v[44:47]
    v_cvt_pk_bf16_f32 v136, v2, v6
    v_cvt_pk_bf16_f32 v137, v10, v14
    v_mfma_f32_16x16x32_bf16 v[48:51], v[168:171], a[68:71], v[48:51]
    v_cvt_pk_bf16_f32 v138, v18, v22
    v_cvt_pk_bf16_f32 v139, v26, v30
    v_mfma_f32_16x16x32_bf16 v[52:55], v[172:175], a[68:71], v[52:55]
    v_cvt_pk_bf16_f32 v140, v3, v7
    v_cvt_pk_bf16_f32 v141, v11, v15
    v_mfma_f32_16x16x32_bf16 v[56:59], v[176:179], a[68:71], v[56:59]
    v_cvt_pk_bf16_f32 v142, v19, v23
    v_cvt_pk_bf16_f32 v143, v27, v31
    v_mfma_f32_16x16x32_bf16 v[60:63], v[180:183], a[68:71], v[60:63]
    v_cvt_pk_bf16_f32 v144, v32, v36
    v_cvt_pk_bf16_f32 v145, v40, v44
    v_mfma_f32_16x16x32_bf16 v[64:67], v[224:227], a[72:75], v[64:67]
    v_cvt_pk_bf16_f32 v146, v48, v52
    v_cvt_pk_bf16_f32 v148, v33, v37
    v_mfma_f32_16x16x32_bf16 v[68:71], v[228:231], a[72:75], v[68:71]
    v_cvt_pk_bf16_f32 v149, v41, v45
    v_cvt_pk_bf16_f32 v150, v49, v53
    v_mfma_f32_16x16x32_bf16 v[72:75], v[160:163], a[72:75], v[72:75]
    v_cvt_pk_bf16_f32 v147, v56, v60
    v_cvt_pk_bf16_f32 v151, v57, v61
    v_mfma_f32_16x16x32_bf16 v[76:79], v[164:167], a[72:75], v[76:79]
    v_cvt_pk_bf16_f32 v152, v34, v38
    v_cvt_pk_bf16_f32 v153, v42, v46
    v_mfma_f32_16x16x32_bf16 v[80:83], v[168:171], a[72:75], v[80:83]
    v_cvt_pk_bf16_f32 v154, v50, v54
    v_cvt_pk_bf16_f32 v155, v58, v62
    v_mfma_f32_16x16x32_bf16 v[84:87], v[172:175], a[72:75], v[84:87]
    v_cvt_pk_bf16_f32 v156, v35, v39
    v_cvt_pk_bf16_f32 v157, v43, v47
    v_mfma_f32_16x16x32_bf16 v[88:91], v[176:179], a[72:75], v[88:91]
    v_cvt_pk_bf16_f32 v158, v51, v55
    v_cvt_pk_bf16_f32 v159, v59, v63
    v_mfma_f32_16x16x32_bf16 v[92:95], v[180:183], a[72:75], v[92:95]
    v_mfma_f32_16x16x32_bf16 v[96:99], v[224:227], a[76:79], v[96:99]
    v_mfma_f32_16x16x32_bf16 v[100:103], v[228:231], a[76:79], v[100:103]
    v_mfma_f32_16x16x32_bf16 v[104:107], v[160:163], a[76:79], v[104:107]
    v_cvt_pk_bf16_f32 v160, v64, v68
    v_cvt_pk_bf16_f32 v161, v72, v76
    v_mfma_f32_16x16x32_bf16 v[108:111], v[164:167], a[76:79], v[108:111]
    v_cvt_pk_bf16_f32 v162, v80, v84
    v_cvt_pk_bf16_f32 v164, v65, v69
    v_mfma_f32_16x16x32_bf16 v[112:115], v[168:171], a[76:79], v[112:115]
    v_cvt_pk_bf16_f32 v163, v88, v92
    v_cvt_pk_bf16_f32 v165, v73, v77
    v_mfma_f32_16x16x32_bf16 v[116:119], v[172:175], a[76:79], v[116:119]
    v_cvt_pk_bf16_f32 v166, v81, v85
    v_cvt_pk_bf16_f32 v167, v89, v93
    v_mfma_f32_16x16x32_bf16 v[120:123], v[176:179], a[76:79], v[120:123]
    buffer_store_dwordx4 a[84:87], v255, s[60:63], s35 offen offset:0 sc1
    v_cvt_pk_bf16_f32 v168, v66, v70
    v_mfma_f32_16x16x32_bf16 v[124:127], v[180:183], a[76:79], v[124:127]
    v_cvt_pk_bf16_f32 v169, v74, v78
    v_cvt_pk_bf16_f32 v170, v82, v86
    v_mfma_f32_16x16x32_bf16 v[32:35], a[96:99], v[144:147], 0
    buffer_store_dwordx4 a[84:87], v255, s[60:63], s35 offen offset:1024 sc1
    s_lshl_b32 s72, s64, 14
    v_add_u32 v250, s72, v129
    v_mfma_f32_16x16x32_bf16 v[36:39], a[112:115], v[144:147], 0
    ds_write_b128 v250, a[32:35] offset:0
    buffer_load_dword v220, off, s[28:31], s3 sc1
    s_mov_b32 s37, 35840
    s_mov_b32 s38, 71680
    s_mov_b32 s39, 107520
    s_mov_b32 s40, 147456
    s_mov_b32 s41, 183296
    s_mov_b32 s42, 219136
    s_mov_b32 s43, 254976
    s_mov_b32 s44, 294912
    s_mov_b32 s45, 330752
    s_mov_b32 s46, 366592
    s_mov_b32 s47, 402432
    s_mov_b32 s48, 442368
    s_mov_b32 s49, 478208
    s_mov_b32 s50, 514048
    s_mov_b32 s51, 549888
    s_lshl_b32 s32, s91, 10
    s_lshl_b32 s70, s64, 5
    s_add_u32 s32, s32, s70
    s_add_u32 s32, s32, 33554432
    s_and_b32 s70, s67, 7
    s_cmp_eq_u32 s70, 7
    s_cselect_b32 s35, 3, s70
    s_lshl_b32 s70, s66, 9
    s_lshl_b32 s71, s67, 5
    s_add_u32 s70, s70, s71
    s_lshl_b32 s71, s64, 3
    s_add_u32 s70, s70, s71
    s_mul_i32 s70, s70, 1152
    s_lshl_b32 s71, s66, 7
    s_add_u32 s70, s70, s71
    v_mfma_f32_16x16x32_bf16 v[40:43], a[128:131], v[144:147], 0
    v_xor_b32 v249, 128, v250
    v_and_b32 v129, 7, v128
    v_mfma_f32_16x16x32_bf16 v[44:47], a[144:147], v[144:147], 0
    ds_write_b128 v249, a[36:39] offset:1024
    v_mfma_f32_16x16x32_bf16 v[32:35], a[100:103], v[148:151], v[32:35]
    v_lshlrev_b32 v129, 5, v129
    v_lshl_add_u32 v129, v128, 8, v129
    v_mfma_f32_16x16x32_bf16 v[36:39], a[116:119], v[148:151], v[36:39]
    v_and_b32 v128, 3, v240
    v_lshl_add_u32 v129, v128, 3, v129
    v_mfma_f32_16x16x32_bf16 v[40:43], a[132:135], v[148:151], v[40:43]
    ds_write_b128 v250, a[40:43] offset:2048
    v_mfma_f32_16x16x32_bf16 v[44:47], a[148:151], v[148:151], v[44:47]
    v_add_u32 v241, s72, v129
    v_lshlrev_b32 v128, 4, v240
    v_mfma_f32_16x16x32_bf16 v[32:35], a[104:107], v[152:155], v[32:35]
    v_add_u32 v251, s72, v128
    v_xor_b32 v242, 32, v241
    v_mfma_f32_16x16x32_bf16 v[36:39], a[120:123], v[152:155], v[36:39]
    ds_write_b128 v249, a[44:47] offset:3072
    v_mfma_f32_16x16x32_bf16 v[40:43], a[136:139], v[152:155], v[40:43]
    v_xor_b32 v243, 64, v241
    v_xor_b32 v244, 96, v241
    v_mfma_f32_16x16x32_bf16 v[44:47], a[152:155], v[152:155], v[44:47]
    v_xor_b32 v245, 128, v241
    v_xor_b32 v246, 160, v241
    v_mfma_f32_16x16x32_bf16 v[32:35], a[108:111], v[156:159], v[32:35]
    ds_write_b128 v250, a[48:51] offset:4096
    buffer_load_dword a80, v217, s[52:55], s70 offen
    s_add_u32 m0, s89, 0
    v_mfma_f32_16x16x32_bf16 v[36:39], a[124:127], v[156:159], v[36:39]
    v_xor_b32 v247, 192, v241
    v_xor_b32 v248, 224, v241
    v_mfma_f32_16x16x32_bf16 v[40:43], a[140:143], v[156:159], v[40:43]
    v_cvt_pk_bf16_f32 v128, v0, v4
    v_cvt_pk_bf16_f32 v129, v8, v12
    v_mfma_f32_16x16x32_bf16 v[44:47], a[156:159], v[156:159], v[44:47]
    ds_write_b128 v249, a[52:55] offset:5120
    v_mfma_f32_16x16x32_bf16 v[0:3], a[96:99], v[128:131], 0
    v_cvt_pk_bf16_f32 v171, v90, v94
    v_cvt_pk_bf16_f32 v172, v67, v71
    v_mfma_f32_16x16x32_bf16 v[4:7], a[112:115], v[128:131], 0
    v_cvt_pk_bf16_f32 v173, v75, v79
    v_cvt_pk_bf16_f32 v174, v83, v87
    v_mfma_f32_16x16x32_bf16 v[8:11], a[128:131], v[128:131], 0
    ds_write_b128 v250, a[56:59] offset:6144
    buffer_load_dwordx4 v223, s[52:55], 0 offen offset:0 lds
    v_mfma_f32_16x16x32_bf16 v[12:15], a[144:147], v[128:131], 0
    v_cvt_pk_bf16_f32 v175, v91, v95
    v_cvt_pk_bf16_f32 v176, v96, v100
    v_mfma_f32_16x16x32_bf16 v[0:3], a[100:103], v[132:135], v[0:3]
    v_cvt_pk_bf16_f32 v177, v104, v108
    v_cvt_pk_bf16_f32 v178, v112, v116
    v_mfma_f32_16x16x32_bf16 v[4:7], a[116:119], v[132:135], v[4:7]
    ds_write_b128 v249, a[60:63] offset:7168
    ds_read_b64_tr_b16 a[192:193], v241 offset:0
    v_mfma_f32_16x16x32_bf16 v[8:11], a[132:135], v[132:135], v[8:11]
    ds_read_b64_tr_b16 a[194:195], v241 offset:4096
    v_cvt_pk_bf16_f32 v179, v120, v124
    v_mfma_f32_16x16x32_bf16 v[12:15], a[148:151], v[132:135], v[12:15]
    ds_read_b64_tr_b16 a[200:201], v242 offset:0
    v_cvt_pk_bf16_f32 v180, v97, v101
    v_mfma_f32_16x16x32_bf16 v[0:3], a[104:107], v[136:139], v[0:3]
    ds_read_b64_tr_b16 a[202:203], v242 offset:4096
    v_cvt_pk_bf16_f32 v181, v105, v109
    v_mfma_f32_16x16x32_bf16 v[4:7], a[120:123], v[136:139], v[4:7]
    ds_read_b64_tr_b16 a[208:209], v243 offset:0
    buffer_load_dwordx4 v223, s[52:55], s37 offen offset:1024 lds
    v_cvt_pk_bf16_f32 v182, v113, v117
    v_mfma_f32_16x16x32_bf16 v[8:11], a[136:139], v[136:139], v[8:11]
    ds_read_b64_tr_b16 a[210:211], v243 offset:4096
    v_cvt_pk_bf16_f32 v183, v121, v125
    v_mfma_f32_16x16x32_bf16 v[12:15], a[152:155], v[136:139], v[12:15]
    ds_read_b64_tr_b16 a[216:217], v244 offset:0
    v_cvt_pk_bf16_f32 v184, v98, v102
    v_mfma_f32_16x16x32_bf16 v[0:3], a[108:111], v[140:143], v[0:3]
    ds_read_b64_tr_b16 a[218:219], v244 offset:4096
    v_cvt_pk_bf16_f32 v185, v106, v110
    v_mfma_f32_16x16x32_bf16 v[4:7], a[124:127], v[140:143], v[4:7]
    ds_read_b64_tr_b16 a[224:225], v245 offset:0
    v_cvt_pk_bf16_f32 v186, v114, v118
    v_mfma_f32_16x16x32_bf16 v[8:11], a[140:143], v[140:143], v[8:11]
    ds_read_b64_tr_b16 a[226:227], v245 offset:4096
    v_cvt_pk_bf16_f32 v187, v122, v126
    v_mfma_f32_16x16x32_bf16 v[12:15], a[156:159], v[140:143], v[12:15]
    ds_read_b64_tr_b16 a[232:233], v246 offset:0
    v_max3_f32 v224, v0, v1, v2
    v_mfma_f32_16x16x32_bf16 v[64:67], a[96:99], v[160:163], 0
    ds_read_b64_tr_b16 a[234:235], v246 offset:4096
    buffer_load_dwordx4 v223, s[52:55], s38 offen offset:2048 lds
    v_max3_f32 v225, v3, v4, v5
    v_mfma_f32_16x16x32_bf16 v[68:71], a[112:115], v[160:163], 0
    ds_read_b64_tr_b16 a[240:241], v247 offset:0
    v_max3_f32 v224, v224, v6, v7
    v_mfma_f32_16x16x32_bf16 v[72:75], a[128:131], v[160:163], 0
    ds_read_b64_tr_b16 a[242:243], v247 offset:4096
    v_max3_f32 v225, v225, v8, v9
    v_mfma_f32_16x16x32_bf16 v[76:79], a[144:147], v[160:163], 0
    ds_read_b64_tr_b16 a[248:249], v248 offset:0
    v_max3_f32 v224, v224, v10, v11
    v_mfma_f32_16x16x32_bf16 v[64:67], a[100:103], v[164:167], v[64:67]
    ds_read_b64_tr_b16 a[250:251], v248 offset:4096
    v_max3_f32 v225, v225, v12, v13
    v_mfma_f32_16x16x32_bf16 v[68:71], a[116:119], v[164:167], v[68:71]
    v_max3_f32 v224, v224, v14, v15
    v_max_f32 v224, v224, v225
    v_mfma_f32_16x16x32_bf16 v[72:75], a[132:135], v[164:167], v[72:75]
    v_mov_b32 v225, v224
    v_cvt_pk_bf16_f32 v188, v99, v103
    v_mfma_f32_16x16x32_bf16 v[76:79], a[148:151], v[164:167], v[76:79]
    buffer_load_dwordx4 v223, s[52:55], s39 offen offset:3072 lds
    s_add_u32 m0, s89, 4096
    v_permlane16_swap_b32 v224, v225
    v_mfma_f32_16x16x32_bf16 v[64:67], a[104:107], v[168:171], v[64:67]
    v_max_f32 v224, v224, v225
    v_mov_b32 v225, v224
    v_mfma_f32_16x16x32_bf16 v[68:71], a[120:123], v[168:171], v[68:71]
    v_cvt_pk_bf16_f32 v189, v107, v111
    v_permlane32_swap_b32 v224, v225
    v_mfma_f32_16x16x32_bf16 v[72:75], a[136:139], v[168:171], v[72:75]
    v_max_f32 v224, v224, v225
    s_waitcnt vmcnt(8)
    v_mul_f32 v224, s90, v224
    v_mfma_f32_16x16x32_bf16 v[76:79], a[152:155], v[168:171], v[76:79]
    ds_read_b64_tr_b16 a[196:197], v241 offset:8192
    v_cvt_pk_bf16_f32 v190, v115, v119
    v_mfma_f32_16x16x32_bf16 v[64:67], a[108:111], v[172:175], v[64:67]
    ds_read_b64_tr_b16 a[198:199], v241 offset:12288
    v_cvt_pk_bf16_f32 v191, v123, v127
    v_mfma_f32_16x16x32_bf16 v[68:71], a[124:127], v[172:175], v[68:71]
    ds_read_b64_tr_b16 a[204:205], v242 offset:8192
    v_max3_f32 v228, v32, v33, v34
    v_mfma_f32_16x16x32_bf16 v[72:75], a[140:143], v[172:175], v[72:75]
    ds_read_b64_tr_b16 a[206:207], v242 offset:12288
    buffer_load_dwordx4 v223, s[52:55], s40 offen offset:0 lds
    v_max3_f32 v229, v35, v36, v37
    v_mfma_f32_16x16x32_bf16 v[76:79], a[156:159], v[172:175], v[76:79]
    ds_read_b64_tr_b16 a[212:213], v243 offset:8192
    v_max3_f32 v228, v228, v38, v39
    v_mfma_f32_16x16x32_bf16 v[96:99], a[96:99], v[176:179], 0
    ds_read_b64_tr_b16 a[214:215], v243 offset:12288
    v_max3_f32 v229, v229, v40, v41
    v_mfma_f32_16x16x32_bf16 v[100:103], a[112:115], v[176:179], 0
    ds_read_b64_tr_b16 a[220:221], v244 offset:8192
    v_max3_f32 v228, v228, v42, v43
    v_mfma_f32_16x16x32_bf16 v[104:107], a[128:131], v[176:179], 0
    ds_read_b64_tr_b16 a[222:223], v244 offset:12288
    v_max3_f32 v229, v229, v44, v45
    v_mfma_f32_16x16x32_bf16 v[108:111], a[144:147], v[176:179], 0
    ds_read_b64_tr_b16 a[228:229], v245 offset:8192
    v_max3_f32 v228, v228, v46, v47
    v_mfma_f32_16x16x32_bf16 v[96:99], a[100:103], v[180:183], v[96:99]
    ds_read_b64_tr_b16 a[230:231], v245 offset:12288
    v_max_f32 v228, v228, v229
    v_mfma_f32_16x16x32_bf16 v[100:103], a[116:119], v[180:183], v[100:103]
    ds_read_b64_tr_b16 a[236:237], v246 offset:8192
    buffer_load_dwordx4 v223, s[52:55], s41 offen offset:1024 lds
    v_mov_b32 v229, v228
    v_mfma_f32_16x16x32_bf16 v[104:107], a[132:135], v[180:183], v[104:107]
    ds_read_b64_tr_b16 a[238:239], v246 offset:12288
    v_permlane16_swap_b32 v228, v229
    v_mfma_f32_16x16x32_bf16 v[108:111], a[148:151], v[180:183], v[108:111]
    ds_read_b64_tr_b16 a[244:245], v247 offset:8192
    v_max_f32 v228, v228, v229
    v_mfma_f32_16x16x32_bf16 v[96:99], a[104:107], v[184:187], v[96:99]
    ds_read_b64_tr_b16 a[246:247], v247 offset:12288
    v_mov_b32 v229, v228
    v_mfma_f32_16x16x32_bf16 v[100:103], a[120:123], v[184:187], v[100:103]
    ds_read_b64_tr_b16 a[252:253], v248 offset:8192
    v_permlane32_swap_b32 v228, v229
    v_mfma_f32_16x16x32_bf16 v[104:107], a[136:139], v[184:187], v[104:107]
    ds_read_b64_tr_b16 a[254:255], v248 offset:12288
    v_max_f32 v228, v228, v229
    v_mfma_f32_16x16x32_bf16 v[108:111], a[152:155], v[184:187], v[108:111]
    v_mul_f32 v228, s90, v228
    v_max3_f32 v232, v64, v65, v66
    v_mfma_f32_16x16x32_bf16 v[96:99], a[108:111], v[188:191], v[96:99]
    buffer_load_dwordx4 v223, s[52:55], s42 offen offset:2048 lds
    v_max3_f32 v233, v67, v68, v69
    v_mfma_f32_16x16x32_bf16 v[100:103], a[124:127], v[188:191], v[100:103]
    v_max3_f32 v232, v232, v70, v71
    v_max3_f32 v233, v233, v72, v73
    v_mfma_f32_16x16x32_bf16 v[104:107], a[140:143], v[188:191], v[104:107]
    v_max3_f32 v232, v232, v74, v75
    v_max3_f32 v233, v233, v76, v77
    v_mfma_f32_16x16x32_bf16 v[108:111], a[156:159], v[188:191], v[108:111]
    v_max3_f32 v232, v232, v78, v79
    v_max_f32 v232, v232, v233
    v_mov_b32 v233, v232
    v_max3_f32 v236, v96, v97, v98
    v_pk_fma_f32 v[0:1], v[0:1], s[90:91], v[224:225] op_sel_hi:[1,0,0] neg_lo:[0,0,1] neg_hi:[0,0,1]
    v_pk_fma_f32 v[2:3], v[2:3], s[90:91], v[224:225] op_sel_hi:[1,0,0] neg_lo:[0,0,1] neg_hi:[0,0,1]
    v_pk_fma_f32 v[4:5], v[4:5], s[90:91], v[224:225] op_sel_hi:[1,0,0] neg_lo:[0,0,1] neg_hi:[0,0,1]
    v_pk_fma_f32 v[6:7], v[6:7], s[90:91], v[224:225] op_sel_hi:[1,0,0] neg_lo:[0,0,1] neg_hi:[0,0,1]
    v_pk_fma_f32 v[8:9], v[8:9], s[90:91], v[224:225] op_sel_hi:[1,0,0] neg_lo:[0,0,1] neg_hi:[0,0,1]
    v_pk_fma_f32 v[10:11], v[10:11], s[90:91], v[224:225] op_sel_hi:[1,0,0] neg_lo:[0,0,1] neg_hi:[0,0,1]
    v_pk_fma_f32 v[12:13], v[12:13], s[90:91], v[224:225] op_sel_hi:[1,0,0] neg_lo:[0,0,1] neg_hi:[0,0,1]
    v_pk_fma_f32 v[14:15], v[14:15], s[90:91], v[224:225] op_sel_hi:[1,0,0] neg_lo:[0,0,1] neg_hi:[0,0,1]
    v_exp_f32 v0, v0
    v_exp_f32 v1, v1
    v_exp_f32 v2, v2
    v_exp_f32 v3, v3
    v_exp_f32 v4, v4
    v_exp_f32 v5, v5
    v_exp_f32 v6, v6
    v_exp_f32 v7, v7
    v_exp_f32 v8, v8
    v_exp_f32 v9, v9
    v_exp_f32 v10, v10
    v_exp_f32 v11, v11
    v_exp_f32 v12, v12
    v_exp_f32 v13, v13
    v_exp_f32 v14, v14
    v_exp_f32 v15, v15
    v_pk_add_f32 v[226:227], v[0:1], v[2:3]
    v_pk_add_f32 v[226:227], v[226:227], v[4:5]
    v_pk_add_f32 v[226:227], v[226:227], v[6:7]
    v_pk_add_f32 v[226:227], v[226:227], v[8:9]
    v_pk_add_f32 v[226:227], v[226:227], v[10:11]
    v_pk_add_f32 v[226:227], v[226:227], v[12:13]
    v_pk_add_f32 v[226:227], v[226:227], v[14:15]
    v_add_f32 v226, v226, v227
    v_mov_b32 v227, v226
    v_pk_fma_f32 v[32:33], v[32:33], s[90:91], v[228:229] op_sel_hi:[1,0,0] neg_lo:[0,0,1] neg_hi:[0,0,1]
    v_pk_fma_f32 v[34:35], v[34:35], s[90:91], v[228:229] op_sel_hi:[1,0,0] neg_lo:[0,0,1] neg_hi:[0,0,1]
    v_permlane16_swap_b32 v226, v227
    v_add_f32 v226, v226, v227
    v_mov_b32 v227, v226
    v_pk_fma_f32 v[36:37], v[36:37], s[90:91], v[228:229] op_sel_hi:[1,0,0] neg_lo:[0,0,1] neg_hi:[0,0,1]
    v_pk_fma_f32 v[38:39], v[38:39], s[90:91], v[228:229] op_sel_hi:[1,0,0] neg_lo:[0,0,1] neg_hi:[0,0,1]
    v_permlane32_swap_b32 v226, v227
    v_add_f32 v226, v226, v227
    v_rcp_f32 v226, v226
    v_pk_fma_f32 v[40:41], v[40:41], s[90:91], v[228:229] op_sel_hi:[1,0,0] neg_lo:[0,0,1] neg_hi:[0,0,1]
    v_pk_mul_f32 v[0:1], v[0:1], v[226:227] op_sel_hi:[1,0]
    v_pk_mul_f32 v[2:3], v[2:3], v[226:227] op_sel_hi:[1,0]
    v_pk_mul_f32 v[4:5], v[4:5], v[226:227] op_sel_hi:[1,0]
    v_pk_mul_f32 v[6:7], v[6:7], v[226:227] op_sel_hi:[1,0]
    v_pk_mul_f32 v[8:9], v[8:9], v[226:227] op_sel_hi:[1,0]
    v_pk_mul_f32 v[10:11], v[10:11], v[226:227] op_sel_hi:[1,0]
    v_pk_mul_f32 v[12:13], v[12:13], v[226:227] op_sel_hi:[1,0]
    v_pk_mul_f32 v[14:15], v[14:15], v[226:227] op_sel_hi:[1,0]
    v_cvt_pk_bf16_f32 v192, v0, v1
    v_cvt_pk_bf16_f32 v193, v2, v3
    v_cvt_pk_bf16_f32 v194, v4, v5
    v_cvt_pk_bf16_f32 v195, v6, v7
    v_cvt_pk_bf16_f32 v196, v8, v9
    v_cvt_pk_bf16_f32 v197, v10, v11
    v_mfma_f32_16x16x32_bf16 v[0:3], a[192:195], v[192:195], 0
    buffer_load_dwordx4 v223, s[52:55], s43 offen offset:3072 lds
    s_add_u32 m0, s89, 32768
    v_cvt_pk_bf16_f32 v198, v12, v13
    v_mfma_f32_16x16x32_bf16 v[4:7], a[200:203], v[192:195], 0
    v_cvt_pk_bf16_f32 v199, v14, v15
    v_exp_f32 v32, v32
    v_mfma_f32_16x16x32_bf16 v[8:11], a[208:211], v[192:195], 0
    v_exp_f32 v33, v33
    v_mfma_f32_16x16x32_bf16 v[12:15], a[216:219], v[192:195], 0
    v_exp_f32 v34, v34
    v_mfma_f32_16x16x32_bf16 v[16:19], a[224:227], v[192:195], 0
    v_exp_f32 v35, v35
    v_mfma_f32_16x16x32_bf16 v[20:23], a[232:235], v[192:195], 0
    v_exp_f32 v36, v36
    v_mfma_f32_16x16x32_bf16 v[24:27], a[240:243], v[192:195], 0
    v_exp_f32 v37, v37
    v_mfma_f32_16x16x32_bf16 v[28:31], a[248:251], v[192:195], 0
    buffer_load_dwordx4 v223, s[52:55], s44 offen offset:0 lds
    v_exp_f32 v38, v38
    s_waitcnt lgkmcnt(14)
    v_mfma_f32_16x16x32_bf16 v[0:3], a[196:199], v[196:199], v[0:3]
    v_exp_f32 v39, v39
    s_waitcnt lgkmcnt(12)
    v_mfma_f32_16x16x32_bf16 v[4:7], a[204:207], v[196:199], v[4:7]
    v_exp_f32 v40, v40
    s_waitcnt lgkmcnt(10)
    v_mfma_f32_16x16x32_bf16 v[8:11], a[212:215], v[196:199], v[8:11]
    v_exp_f32 v41, v41
    s_waitcnt lgkmcnt(8)
    v_mfma_f32_16x16x32_bf16 v[12:15], a[220:223], v[196:199], v[12:15]
    v_permlane16_swap_b32 v232, v233
    s_waitcnt lgkmcnt(6)
    v_mfma_f32_16x16x32_bf16 v[16:19], a[228:231], v[196:199], v[16:19]
    v_cvt_pk_bf16_f32 v128, v0, v1
    v_cvt_pk_bf16_f32 v129, v2, v3
    s_waitcnt lgkmcnt(4)
    v_mfma_f32_16x16x32_bf16 v[20:23], a[236:239], v[196:199], v[20:23]
    v_cvt_pk_bf16_f32 v130, v4, v5
    v_cvt_pk_bf16_f32 v131, v6, v7
    s_waitcnt lgkmcnt(2)
    v_mfma_f32_16x16x32_bf16 v[24:27], a[244:247], v[196:199], v[24:27]
    buffer_load_dwordx4 v223, s[52:55], s45 offen offset:1024 lds
    ds_write_b128 v251, v[128:131] offset:0
    v_pk_fma_f32 v[42:43], v[42:43], s[90:91], v[228:229] op_sel_hi:[1,0,0] neg_lo:[0,0,1] neg_hi:[0,0,1]
    v_pk_fma_f32 v[44:45], v[44:45], s[90:91], v[228:229] op_sel_hi:[1,0,0] neg_lo:[0,0,1] neg_hi:[0,0,1]
    v_pk_fma_f32 v[46:47], v[46:47], s[90:91], v[228:229] op_sel_hi:[1,0,0] neg_lo:[0,0,1] neg_hi:[0,0,1]
    s_waitcnt lgkmcnt(1)
    v_mfma_f32_16x16x32_bf16 v[28:31], a[252:255], v[196:199], v[28:31]
    v_exp_f32 v42, v42
    v_exp_f32 v43, v43
    v_exp_f32 v44, v44
    v_exp_f32 v45, v45
    v_exp_f32 v46, v46
    v_exp_f32 v47, v47
    v_pk_add_f32 v[230:231], v[32:33], v[34:35]
    v_pk_add_f32 v[230:231], v[230:231], v[36:37]
    v_pk_add_f32 v[230:231], v[230:231], v[38:39]
    v_pk_add_f32 v[230:231], v[230:231], v[40:41]
    v_pk_add_f32 v[230:231], v[230:231], v[42:43]
    v_pk_add_f32 v[230:231], v[230:231], v[44:45]
    v_pk_add_f32 v[230:231], v[230:231], v[46:47]
    v_add_f32 v230, v230, v231
    v_mov_b32 v231, v230
    v_cvt_pk_bf16_f32 v132, v8, v9
    v_cvt_pk_bf16_f32 v133, v10, v11
    v_permlane16_swap_b32 v230, v231
    v_add_f32 v230, v230, v231
    v_mov_b32 v231, v230
    v_cvt_pk_bf16_f32 v134, v12, v13
    v_cvt_pk_bf16_f32 v135, v14, v15
    v_permlane32_swap_b32 v230, v231
    v_add_f32 v230, v230, v231
    v_rcp_f32 v230, v230
    v_cvt_pk_bf16_f32 v136, v16, v17
    v_pk_mul_f32 v[32:33], v[32:33], v[230:231] op_sel_hi:[1,0]
    v_pk_mul_f32 v[34:35], v[34:35], v[230:231] op_sel_hi:[1,0]
    v_pk_mul_f32 v[36:37], v[36:37], v[230:231] op_sel_hi:[1,0]
    v_pk_mul_f32 v[38:39], v[38:39], v[230:231] op_sel_hi:[1,0]
    v_pk_mul_f32 v[40:41], v[40:41], v[230:231] op_sel_hi:[1,0]
    v_pk_mul_f32 v[42:43], v[42:43], v[230:231] op_sel_hi:[1,0]
    v_pk_mul_f32 v[44:45], v[44:45], v[230:231] op_sel_hi:[1,0]
    v_pk_mul_f32 v[46:47], v[46:47], v[230:231] op_sel_hi:[1,0]
    v_cvt_pk_bf16_f32 v200, v32, v33
    v_cvt_pk_bf16_f32 v201, v34, v35
    v_cvt_pk_bf16_f32 v202, v36, v37
    v_cvt_pk_bf16_f32 v203, v38, v39
    v_cvt_pk_bf16_f32 v204, v40, v41
    v_cvt_pk_bf16_f32 v205, v42, v43
    v_mfma_f32_16x16x32_bf16 v[32:35], a[192:195], v[200:203], 0
    buffer_load_dwordx4 v223, s[52:55], s46 offen offset:2048 lds
    ds_write_b128 v251, v[132:135] offset:4096
    v_mfma_f32_16x16x32_bf16 v[36:39], a[200:203], v[200:203], 0
    v_cvt_pk_bf16_f32 v206, v44, v45
    v_cvt_pk_bf16_f32 v207, v46, v47
    v_mfma_f32_16x16x32_bf16 v[40:43], a[208:211], v[200:203], 0
    v_cvt_pk_bf16_f32 v137, v18, v19
    v_cvt_pk_bf16_f32 v138, v20, v21
    v_mfma_f32_16x16x32_bf16 v[44:47], a[216:219], v[200:203], 0
    v_cvt_pk_bf16_f32 v139, v22, v23
    v_cvt_pk_bf16_f32 v140, v24, v25
    v_mfma_f32_16x16x32_bf16 v[48:51], a[224:227], v[200:203], 0
    ds_write_b128 v251, v[136:139] offset:8192
    v_mfma_f32_16x16x32_bf16 v[52:55], a[232:235], v[200:203], 0
    v_cvt_pk_bf16_f32 v141, v26, v27
    v_cvt_pk_bf16_f32 v142, v28, v29
    v_mfma_f32_16x16x32_bf16 v[56:59], a[240:243], v[200:203], 0
    buffer_load_dwordx4 v223, s[52:55], s47 offen offset:3072 lds
    s_add_u32 m0, s89, 36864
    v_cvt_pk_bf16_f32 v143, v30, v31
    v_mfma_f32_16x16x32_bf16 v[60:63], a[248:251], v[200:203], 0
    ds_write_b128 v251, v[140:143] offset:12288
    v_mfma_f32_16x16x32_bf16 v[32:35], a[196:199], v[204:207], v[32:35]
    v_max_f32 v232, v232, v233
    v_mov_b32 v233, v232
    v_mfma_f32_16x16x32_bf16 v[36:39], a[204:207], v[204:207], v[36:39]
    v_max3_f32 v237, v99, v100, v101
    v_permlane32_swap_b32 v232, v233
    v_mfma_f32_16x16x32_bf16 v[40:43], a[212:215], v[204:207], v[40:43]
    v_max_f32 v232, v232, v233
    v_mul_f32 v232, s90, v232
    v_mfma_f32_16x16x32_bf16 v[44:47], a[220:223], v[204:207], v[44:47]
    v_cvt_pk_bf16_f32 v144, v32, v33
    v_cvt_pk_bf16_f32 v145, v34, v35
    v_mfma_f32_16x16x32_bf16 v[48:51], a[228:231], v[204:207], v[48:51]
    buffer_load_dwordx4 v223, s[52:55], s48 offen offset:0 lds
    v_cvt_pk_bf16_f32 v146, v36, v37
    v_mfma_f32_16x16x32_bf16 v[52:55], a[236:239], v[204:207], v[52:55]
    v_cvt_pk_bf16_f32 v147, v38, v39
    v_cvt_pk_bf16_f32 v148, v40, v41
    v_mfma_f32_16x16x32_bf16 v[56:59], a[244:247], v[204:207], v[56:59]
    ds_write_b128 v251, v[144:147] offset:1024
    v_pk_fma_f32 v[64:65], v[64:65], s[90:91], v[232:233] op_sel_hi:[1,0,0] neg_lo:[0,0,1] neg_hi:[0,0,1]
    v_pk_fma_f32 v[66:67], v[66:67], s[90:91], v[232:233] op_sel_hi:[1,0,0] neg_lo:[0,0,1] neg_hi:[0,0,1]
    v_pk_fma_f32 v[68:69], v[68:69], s[90:91], v[232:233] op_sel_hi:[1,0,0] neg_lo:[0,0,1] neg_hi:[0,0,1]
    v_pk_fma_f32 v[70:71], v[70:71], s[90:91], v[232:233] op_sel_hi:[1,0,0] neg_lo:[0,0,1] neg_hi:[0,0,1]
    v_pk_fma_f32 v[72:73], v[72:73], s[90:91], v[232:233] op_sel_hi:[1,0,0] neg_lo:[0,0,1] neg_hi:[0,0,1]
    v_pk_fma_f32 v[74:75], v[74:75], s[90:91], v[232:233] op_sel_hi:[1,0,0] neg_lo:[0,0,1] neg_hi:[0,0,1]
    v_pk_fma_f32 v[76:77], v[76:77], s[90:91], v[232:233] op_sel_hi:[1,0,0] neg_lo:[0,0,1] neg_hi:[0,0,1]
    v_pk_fma_f32 v[78:79], v[78:79], s[90:91], v[232:233] op_sel_hi:[1,0,0] neg_lo:[0,0,1] neg_hi:[0,0,1]
    v_mfma_f32_16x16x32_bf16 v[60:63], a[252:255], v[204:207], v[60:63]
    v_exp_f32 v64, v64
    v_exp_f32 v65, v65
    v_exp_f32 v66, v66
    v_exp_f32 v67, v67
    v_exp_f32 v68, v68
    v_exp_f32 v69, v69
    v_exp_f32 v70, v70
    v_exp_f32 v71, v71
    v_exp_f32 v72, v72
    v_exp_f32 v73, v73
    v_exp_f32 v74, v74
    v_exp_f32 v75, v75
    v_exp_f32 v76, v76
    v_exp_f32 v77, v77
    v_exp_f32 v78, v78
    v_exp_f32 v79, v79
    v_pk_add_f32 v[234:235], v[64:65], v[66:67]
    v_pk_add_f32 v[234:235], v[234:235], v[68:69]
    v_pk_add_f32 v[234:235], v[234:235], v[70:71]
    v_pk_add_f32 v[234:235], v[234:235], v[72:73]
    v_pk_add_f32 v[234:235], v[234:235], v[74:75]
    v_pk_add_f32 v[234:235], v[234:235], v[76:77]
    v_pk_add_f32 v[234:235], v[234:235], v[78:79]
    v_add_f32 v234, v234, v235
    v_mov_b32 v235, v234
    v_cvt_pk_bf16_f32 v149, v42, v43
    v_cvt_pk_bf16_f32 v150, v44, v45
    v_permlane16_swap_b32 v234, v235
    v_add_f32 v234, v234, v235
    v_mov_b32 v235, v234
    v_cvt_pk_bf16_f32 v151, v46, v47
    v_cvt_pk_bf16_f32 v152, v48, v49
    v_permlane32_swap_b32 v234, v235
    v_add_f32 v234, v234, v235
    v_rcp_f32 v234, v234
    v_cvt_pk_bf16_f32 v153, v50, v51
    v_pk_mul_f32 v[64:65], v[64:65], v[234:235] op_sel_hi:[1,0]
    v_pk_mul_f32 v[66:67], v[66:67], v[234:235] op_sel_hi:[1,0]
    v_pk_mul_f32 v[68:69], v[68:69], v[234:235] op_sel_hi:[1,0]
    v_pk_mul_f32 v[70:71], v[70:71], v[234:235] op_sel_hi:[1,0]
    v_pk_mul_f32 v[72:73], v[72:73], v[234:235] op_sel_hi:[1,0]
    v_pk_mul_f32 v[74:75], v[74:75], v[234:235] op_sel_hi:[1,0]
    v_pk_mul_f32 v[76:77], v[76:77], v[234:235] op_sel_hi:[1,0]
    v_pk_mul_f32 v[78:79], v[78:79], v[234:235] op_sel_hi:[1,0]
    v_cvt_pk_bf16_f32 v208, v64, v65
    v_cvt_pk_bf16_f32 v209, v66, v67
    v_cvt_pk_bf16_f32 v210, v68, v69
    v_cvt_pk_bf16_f32 v211, v70, v71
    v_cvt_pk_bf16_f32 v212, v72, v73
    v_cvt_pk_bf16_f32 v213, v74, v75
    v_mfma_f32_16x16x32_bf16 v[64:67], a[192:195], v[208:211], 0
    buffer_load_dwordx4 v223, s[52:55], s49 offen offset:1024 lds
    ds_write_b128 v251, v[148:151] offset:5120
    v_mfma_f32_16x16x32_bf16 v[68:71], a[200:203], v[208:211], 0
    v_cvt_pk_bf16_f32 v214, v76, v77
    v_cvt_pk_bf16_f32 v215, v78, v79
    v_mfma_f32_16x16x32_bf16 v[72:75], a[208:211], v[208:211], 0
    v_cvt_pk_bf16_f32 v154, v52, v53
    v_cvt_pk_bf16_f32 v155, v54, v55
    v_mfma_f32_16x16x32_bf16 v[76:79], a[216:219], v[208:211], 0
    ds_write_b128 v251, v[152:155] offset:9216
    v_mfma_f32_16x16x32_bf16 v[80:83], a[224:227], v[208:211], 0
    v_cvt_pk_bf16_f32 v156, v56, v57
    v_cvt_pk_bf16_f32 v157, v58, v59
    v_mfma_f32_16x16x32_bf16 v[84:87], a[232:235], v[208:211], 0
    v_cvt_pk_bf16_f32 v158, v60, v61
    v_cvt_pk_bf16_f32 v159, v62, v63
    v_mfma_f32_16x16x32_bf16 v[88:91], a[240:243], v[208:211], 0
    buffer_load_dwordx4 v223, s[52:55], s50 offen offset:2048 lds
    ds_write_b128 v251, v[156:159] offset:13312
    v_mfma_f32_16x16x32_bf16 v[92:95], a[248:251], v[208:211], 0
    v_max3_f32 v236, v236, v102, v103
    v_max3_f32 v237, v237, v104, v105
    v_mfma_f32_16x16x32_bf16 v[64:67], a[196:199], v[212:215], v[64:67]
    v_max3_f32 v236, v236, v106, v107
    v_max3_f32 v237, v237, v108, v109
    v_mfma_f32_16x16x32_bf16 v[68:71], a[204:207], v[212:215], v[68:71]
    v_max3_f32 v236, v236, v110, v111
    v_max_f32 v236, v236, v237
    v_mfma_f32_16x16x32_bf16 v[72:75], a[212:215], v[212:215], v[72:75]
    v_mov_b32 v237, v236
    v_mfma_f32_16x16x32_bf16 v[76:79], a[220:223], v[212:215], v[76:79]
    v_cvt_pk_bf16_f32 v160, v64, v65
    v_permlane16_swap_b32 v236, v237
    v_mfma_f32_16x16x32_bf16 v[80:83], a[228:231], v[212:215], v[80:83]
    buffer_load_dwordx4 v223, s[52:55], s51 offen offset:3072 lds
    s_add_u32 s69, s35, 1
    s_cmp_gt_u32 s69, 7
    s_cselect_b32 s93, 7, 0
    s_sub_u32 s69, s69, s93
    s_add_u32 s69, s69, s66
    s_and_b32 s69, s69, 7
    s_lshl_b32 s69, s69, 7
    s_add_u32 m0, s89, 65536
    v_mfma_f32_16x16x32_bf16 v[84:87], a[236:239], v[212:215], v[84:87]
    v_add_u32 v223, s69, v252
    v_max_f32 v236, v236, v237
    v_mfma_f32_16x16x32_bf16 v[88:91], a[244:247], v[212:215], v[88:91]
    v_mov_b32 v237, v236
    v_cvt_pk_bf16_f32 v161, v66, v67
    v_mfma_f32_16x16x32_bf16 v[92:95], a[252:255], v[212:215], v[92:95]
    v_permlane32_swap_b32 v236, v237
    v_max_f32 v236, v236, v237
    v_mul_f32 v236, s90, v236
    v_pk_fma_f32 v[96:97], v[96:97], s[90:91], v[236:237] op_sel_hi:[1,0,0] neg_lo:[0,0,1] neg_hi:[0,0,1]
    v_pk_fma_f32 v[98:99], v[98:99], s[90:91], v[236:237] op_sel_hi:[1,0,0] neg_lo:[0,0,1] neg_hi:[0,0,1]
    v_pk_fma_f32 v[100:101], v[100:101], s[90:91], v[236:237] op_sel_hi:[1,0,0] neg_lo:[0,0,1] neg_hi:[0,0,1]
    v_pk_fma_f32 v[102:103], v[102:103], s[90:91], v[236:237] op_sel_hi:[1,0,0] neg_lo:[0,0,1] neg_hi:[0,0,1]
    v_pk_fma_f32 v[104:105], v[104:105], s[90:91], v[236:237] op_sel_hi:[1,0,0] neg_lo:[0,0,1] neg_hi:[0,0,1]
    v_pk_fma_f32 v[106:107], v[106:107], s[90:91], v[236:237] op_sel_hi:[1,0,0] neg_lo:[0,0,1] neg_hi:[0,0,1]
    v_pk_fma_f32 v[108:109], v[108:109], s[90:91], v[236:237] op_sel_hi:[1,0,0] neg_lo:[0,0,1] neg_hi:[0,0,1]
    v_pk_fma_f32 v[110:111], v[110:111], s[90:91], v[236:237] op_sel_hi:[1,0,0] neg_lo:[0,0,1] neg_hi:[0,0,1]
    v_exp_f32 v96, v96
    v_exp_f32 v97, v97
    v_exp_f32 v98, v98
    v_exp_f32 v99, v99
    v_exp_f32 v100, v100
    v_exp_f32 v101, v101
    v_exp_f32 v102, v102
    v_exp_f32 v103, v103
    v_exp_f32 v104, v104
    v_exp_f32 v105, v105
    v_exp_f32 v106, v106
    v_exp_f32 v107, v107
    v_exp_f32 v108, v108
    v_exp_f32 v109, v109
    v_exp_f32 v110, v110
    v_exp_f32 v111, v111
    v_pk_add_f32 v[238:239], v[96:97], v[98:99]
    v_pk_add_f32 v[238:239], v[238:239], v[100:101]
    v_pk_add_f32 v[238:239], v[238:239], v[102:103]
    v_pk_add_f32 v[238:239], v[238:239], v[104:105]
    v_pk_add_f32 v[238:239], v[238:239], v[106:107]
    v_pk_add_f32 v[238:239], v[238:239], v[108:109]
    v_pk_add_f32 v[238:239], v[238:239], v[110:111]
    v_add_f32 v238, v238, v239
    v_mov_b32 v239, v238
    v_cvt_pk_bf16_f32 v162, v68, v69
    v_cvt_pk_bf16_f32 v163, v70, v71
    v_permlane16_swap_b32 v238, v239
    v_add_f32 v238, v238, v239
    v_mov_b32 v239, v238
    v_cvt_pk_bf16_f32 v164, v72, v73
    v_cvt_pk_bf16_f32 v165, v74, v75
    v_permlane32_swap_b32 v238, v239
    v_add_f32 v238, v238, v239
    v_rcp_f32 v238, v238
    v_cvt_pk_bf16_f32 v166, v76, v77
    v_pk_mul_f32 v[96:97], v[96:97], v[238:239] op_sel_hi:[1,0]
    v_pk_mul_f32 v[98:99], v[98:99], v[238:239] op_sel_hi:[1,0]
    v_pk_mul_f32 v[100:101], v[100:101], v[238:239] op_sel_hi:[1,0]
    v_pk_mul_f32 v[102:103], v[102:103], v[238:239] op_sel_hi:[1,0]
    v_pk_mul_f32 v[104:105], v[104:105], v[238:239] op_sel_hi:[1,0]
    v_pk_mul_f32 v[106:107], v[106:107], v[238:239] op_sel_hi:[1,0]
    v_pk_mul_f32 v[108:109], v[108:109], v[238:239] op_sel_hi:[1,0]
    v_pk_mul_f32 v[110:111], v[110:111], v[238:239] op_sel_hi:[1,0]
    v_cvt_pk_bf16_f32 v192, v96, v97
    v_cvt_pk_bf16_f32 v193, v98, v99
    v_cvt_pk_bf16_f32 v194, v100, v101
    v_cvt_pk_bf16_f32 v195, v102, v103
    v_cvt_pk_bf16_f32 v196, v104, v105
    v_cvt_pk_bf16_f32 v197, v106, v107
    v_mfma_f32_16x16x32_bf16 v[96:99], a[192:195], v[192:195], 0
    buffer_load_dwordx4 v223, s[52:55], 0 offen offset:0 lds
    ds_write_b128 v251, v[160:163] offset:2048
    v_mfma_f32_16x16x32_bf16 v[100:103], a[200:203], v[192:195], 0
    v_cvt_pk_bf16_f32 v198, v108, v109
    v_cvt_pk_bf16_f32 v199, v110, v111
    v_mfma_f32_16x16x32_bf16 v[104:107], a[208:211], v[192:195], 0
    v_cvt_pk_bf16_f32 v167, v78, v79
    v_cvt_pk_bf16_f32 v168, v80, v81
    v_mfma_f32_16x16x32_bf16 v[108:111], a[216:219], v[192:195], 0
    ds_write_b128 v251, v[164:167] offset:6144
    v_mfma_f32_16x16x32_bf16 v[112:115], a[224:227], v[192:195], 0
    v_cvt_pk_bf16_f32 v169, v82, v83
    v_cvt_pk_bf16_f32 v170, v84, v85
    v_mfma_f32_16x16x32_bf16 v[116:119], a[232:235], v[192:195], 0
    v_cvt_pk_bf16_f32 v171, v86, v87
    v_cvt_pk_bf16_f32 v172, v88, v89
    v_mfma_f32_16x16x32_bf16 v[120:123], a[240:243], v[192:195], 0
    buffer_load_dwordx4 v223, s[52:55], s37 offen offset:1024 lds
    ds_write_b128 v251, v[168:171] offset:10240
    v_mfma_f32_16x16x32_bf16 v[124:127], a[248:251], v[192:195], 0
    v_cvt_pk_bf16_f32 v173, v90, v91
    v_cvt_pk_bf16_f32 v174, v92, v93
    v_mfma_f32_16x16x32_bf16 v[96:99], a[196:199], v[196:199], v[96:99]
    v_cvt_pk_bf16_f32 v175, v94, v95
    v_mfma_f32_16x16x32_bf16 v[100:103], a[204:207], v[196:199], v[100:103]
    ds_write_b128 v251, v[172:175] offset:14336
    v_mfma_f32_16x16x32_bf16 v[104:107], a[212:215], v[196:199], v[104:107]
    v_mfma_f32_16x16x32_bf16 v[108:111], a[220:223], v[196:199], v[108:111]
    v_mfma_f32_16x16x32_bf16 v[112:115], a[228:231], v[196:199], v[112:115]
    buffer_load_dwordx4 v223, s[52:55], s38 offen offset:2048 lds
    v_mfma_f32_16x16x32_bf16 v[116:119], a[236:239], v[196:199], v[116:119]
    v_cvt_pk_bf16_f32 v176, v96, v97
    v_cvt_pk_bf16_f32 v177, v98, v99
    v_mfma_f32_16x16x32_bf16 v[120:123], a[244:247], v[196:199], v[120:123]
    v_cvt_pk_bf16_f32 v178, v100, v101
    v_cvt_pk_bf16_f32 v179, v102, v103
    v_mfma_f32_16x16x32_bf16 v[124:127], a[252:255], v[196:199], v[124:127]
    ds_write_b128 v251, v[176:179] offset:3072
    v_cvt_pk_bf16_f32 v180, v104, v105
    v_cvt_pk_bf16_f32 v181, v106, v107
    v_cvt_pk_bf16_f32 v182, v108, v109
    v_cvt_pk_bf16_f32 v183, v110, v111
    v_cvt_pk_bf16_f32 v184, v112, v113
    v_cvt_pk_bf16_f32 v185, v114, v115
    v_cvt_pk_bf16_f32 v186, v116, v117
    v_cvt_pk_bf16_f32 v187, v118, v119
    v_cvt_pk_bf16_f32 v188, v120, v121
    ds_write_b128 v251, v[180:183] offset:7168
    buffer_load_dwordx4 v223, s[52:55], s39 offen offset:3072 lds
    s_add_u32 m0, s89, 69632
    v_cvt_pk_bf16_f32 v189, v122, v123
    v_cvt_pk_bf16_f32 v190, v124, v125
    v_cvt_pk_bf16_f32 v191, v126, v127
    ds_write_b128 v251, v[184:187] offset:11264
    ds_write_b128 v251, v[188:191] offset:15360
    buffer_load_dwordx4 v223, s[52:55], s40 offen offset:0 lds
    buffer_load_dwordx4 v223, s[52:55], s41 offen offset:1024 lds
    buffer_load_dwordx4 v223, s[52:55], s42 offen offset:2048 lds
    buffer_load_dwordx4 v223, s[52:55], s43 offen offset:3072 lds
    v_add_u32 v254, 65536, v253
    s_waitcnt lgkmcnt(0)
    s_waitcnt vmcnt(25)
    v_readfirstlane_b32 s101, v220
    s_nop 0
    s_cmp_lg_u32 s101, 0
    s_cbranch_scc0 L_spin0
L_back0:
    s_waitcnt vmcnt(16)
    s_barrier
    s_mov_b32 s100, s85
    ds_read_b64_tr_b16 v[192:193], v253 offset:0
    ds_read_b64_tr_b16 v[194:195], v253 offset:512
    ds_read_b128 a[0:3], v222 offset:0
    ds_read_b128 a[64:67], v222 offset:1024
    ds_read_b128 a[128:131], v222 offset:2048
    ds_read_b128 a[192:195], v222 offset:3072
    ds_read_b64_tr_b16 v[196:197], v253 offset:1024
    ds_read_b64_tr_b16 v[198:199], v253 offset:1536
    ds_read_b128 a[4:7], v222 offset:4096
    ds_read_b128 a[68:71], v222 offset:5120
    ds_read_b128 a[132:135], v222 offset:6144
    ds_read_b128 a[196:199], v222 offset:7168
    ds_read_b64_tr_b16 v[200:201], v253 offset:2048
    ds_read_b64_tr_b16 v[202:203], v253 offset:2560
    s_waitcnt lgkmcnt(11)
    v_mfma_f32_16x16x32_bf16 v[0:3], v[192:195], a[0:3], 0
    ds_read_b128 a[8:11], v222 offset:8192
    ds_read_b128 a[72:75], v222 offset:9216
    s_waitcnt lgkmcnt(12)
    v_mfma_f32_16x16x32_bf16 v[4:7], v[192:195], a[64:67], 0
    ds_read_b128 a[136:139], v222 offset:10240
    ds_read_b128 a[200:203], v222 offset:11264
    s_waitcnt lgkmcnt(13)
    v_mfma_f32_16x16x32_bf16 v[8:11], v[192:195], a[128:131], 0
    ds_read_b64_tr_b16 v[204:205], v253 offset:3072
    ds_read_b64_tr_b16 v[206:207], v253 offset:3584
    s_waitcnt lgkmcnt(14)
    v_mfma_f32_16x16x32_bf16 v[12:15], v[192:195], a[192:195], 0
    s_waitcnt lgkmcnt(11)
    v_mfma_f32_16x16x32_bf16 v[0:3], v[196:199], a[4:7], v[0:3]
    ds_read_b128 a[12:15], v222 offset:12288
    ds_read_b128 a[76:79], v222 offset:13312
    s_waitcnt lgkmcnt(12)
    v_mfma_f32_16x16x32_bf16 v[4:7], v[196:199], a[68:71], v[4:7]
    ds_read_b128 a[140:143], v222 offset:14336
    ds_read_b128 a[204:207], v222 offset:15360
    s_waitcnt lgkmcnt(13)
    v_mfma_f32_16x16x32_bf16 v[8:11], v[196:199], a[132:135], v[8:11]
    ds_read_b64_tr_b16 v[192:193], v253 offset:4096
    ds_read_b64_tr_b16 v[194:195], v253 offset:4608
    s_waitcnt lgkmcnt(14)
    v_mfma_f32_16x16x32_bf16 v[12:15], v[196:199], a[196:199], v[12:15]
    s_waitcnt lgkmcnt(11)
    v_mfma_f32_16x16x32_bf16 v[0:3], v[200:203], a[8:11], v[0:3]
    ds_read_b128 a[16:19], v222 offset:16384
    ds_read_b128 a[80:83], v222 offset:17408
    s_waitcnt lgkmcnt(12)
    v_mfma_f32_16x16x32_bf16 v[4:7], v[200:203], a[72:75], v[4:7]
    ds_read_b128 a[144:147], v222 offset:18432
    ds_read_b128 a[208:211], v222 offset:19456
    s_waitcnt lgkmcnt(13)
    v_mfma_f32_16x16x32_bf16 v[8:11], v[200:203], a[136:139], v[8:11]
    ds_read_b64_tr_b16 v[196:197], v253 offset:5120
    ds_read_b64_tr_b16 v[198:199], v253 offset:5632
    s_waitcnt lgkmcnt(14)
    v_mfma_f32_16x16x32_bf16 v[12:15], v[200:203], a[200:203], v[12:15]
    s_waitcnt lgkmcnt(11)
    v_mfma_f32_16x16x32_bf16 v[0:3], v[204:207], a[12:15], v[0:3]
    ds_read_b128 a[20:23], v222 offset:20480
    ds_read_b128 a[84:87], v222 offset:21504
    s_waitcnt lgkmcnt(12)
    v_mfma_f32_16x16x32_bf16 v[4:7], v[204:207], a[76:79], v[4:7]
    ds_read_b128 a[148:151], v222 offset:22528
    ds_read_b128 a[212:215], v222 offset:23552
    s_waitcnt lgkmcnt(13)
    v_mfma_f32_16x16x32_bf16 v[8:11], v[204:207], a[140:143], v[8:11]
    ds_read_b64_tr_b16 v[200:201], v253 offset:6144
    ds_read_b64_tr_b16 v[202:203], v253 offset:6656
    s_waitcnt lgkmcnt(14)
    v_mfma_f32_16x16x32_bf16 v[12:15], v[204:207], a[204:207], v[12:15]
    s_waitcnt lgkmcnt(11)
    v_mfma_f32_16x16x32_bf16 v[0:3], v[192:195], a[16:19], v[0:3]
    ds_read_b128 a[24:27], v222 offset:24576
    ds_read_b128 a[88:91], v222 offset:25600
    s_waitcnt lgkmcnt(12)
    v_mfma_f32_16x16x32_bf16 v[4:7], v[192:195], a[80:83], v[4:7]
    ds_read_b128 a[152:155], v222 offset:26624
    ds_read_b128 a[216:219], v222 offset:27648
    s_waitcnt lgkmcnt(13)
    v_mfma_f32_16x16x32_bf16 v[8:11], v[192:195], a[144:147], v[8:11]
    ds_read_b64_tr_b16 v[204:205], v253 offset:7168
    ds_read_b64_tr_b16 v[206:207], v253 offset:7680
    s_waitcnt lgkmcnt(14)
    v_mfma_f32_16x16x32_bf16 v[12:15], v[192:195], a[208:211], v[12:15]
    s_waitcnt lgkmcnt(11)
    v_mfma_f32_16x16x32_bf16 v[0:3], v[196:199], a[20:23], v[0:3]
    ds_read_b128 a[28:31], v222 offset:28672
    s_waitcnt lgkmcnt(11)
    v_mfma_f32_16x16x32_bf16 v[4:7], v[196:199], a[84:87], v[4:7]
    ds_read_b128 a[92:95], v222 offset:29696
    s_waitcnt lgkmcnt(11)
    v_mfma_f32_16x16x32_bf16 v[8:11], v[196:199], a[148:151], v[8:11]
    ds_read_b128 a[156:159], v222 offset:30720
    s_waitcnt lgkmcnt(11)
    v_mfma_f32_16x16x32_bf16 v[12:15], v[196:199], a[212:215], v[12:15]
    ds_read_b128 a[220:223], v222 offset:31744
    s_waitcnt lgkmcnt(4)
    s_waitcnt vmcnt(8)
    s_barrier
    v_mfma_f32_16x16x32_bf16 v[0:3], v[200:203], a[24:27], v[0:3]
    ds_read_b128 a[32:35], v222 offset:32768
    ds_read_b128 a[96:99], v222 offset:33792
    ds_read_b128 a[160:163], v222 offset:34816
    v_mfma_f32_16x16x32_bf16 v[4:7], v[200:203], a[88:91], v[4:7]
    ds_read_b128 a[224:227], v222 offset:35840
    ds_read_b64_tr_b16 v[192:193], v253 offset:32768
    ds_read_b64_tr_b16 v[194:195], v253 offset:33280
    v_mfma_f32_16x16x32_bf16 v[8:11], v[200:203], a[152:155], v[8:11]
    ds_read_b64_tr_b16 v[196:197], v253 offset:33792
    ds_read_b64_tr_b16 v[198:199], v253 offset:34304
    s_add_u32 m0, s89, 0
    v_mfma_f32_16x16x32_bf16 v[12:15], v[200:203], a[216:219], v[12:15]
    buffer_load_dwordx4 v223, s[52:55], s44 offen offset:0 lds
    s_waitcnt lgkmcnt(11)
    v_mfma_f32_16x16x32_bf16 v[0:3], v[204:207], a[28:31], v[0:3]
    ds_read_b128 a[36:39], v222 offset:36864
    ds_read_b128 a[100:103], v222 offset:37888
    s_waitcnt lgkmcnt(12)
    v_mfma_f32_16x16x32_bf16 v[4:7], v[204:207], a[92:95], v[4:7]
    ds_read_b128 a[164:167], v222 offset:38912
    ds_read_b128 a[228:231], v222 offset:39936
    s_waitcnt lgkmcnt(13)
    v_mfma_f32_16x16x32_bf16 v[8:11], v[204:207], a[156:159], v[8:11]
    ds_read_b64_tr_b16 v[200:201], v253 offset:34816
    ds_read_b64_tr_b16 v[202:203], v253 offset:35328
    s_waitcnt lgkmcnt(14)
    v_mfma_f32_16x16x32_bf16 v[12:15], v[204:207], a[220:223], v[12:15]
    buffer_load_dwordx4 v223, s[52:55], s45 offen offset:1024 lds
    s_waitcnt lgkmcnt(8)
    v_mfma_f32_16x16x32_bf16 v[0:3], v[192:195], a[32:35], v[0:3]
    ds_read_b128 a[40:43], v222 offset:40960
    ds_read_b128 a[104:107], v222 offset:41984
    v_mfma_f32_16x16x32_bf16 v[4:7], v[192:195], a[96:99], v[4:7]
    ds_read_b128 a[168:171], v222 offset:43008
    ds_read_b128 a[232:235], v222 offset:44032
    v_mfma_f32_16x16x32_bf16 v[8:11], v[192:195], a[160:163], v[8:11]
    ds_read_b64_tr_b16 v[204:205], v253 offset:35840
    ds_read_b64_tr_b16 v[206:207], v253 offset:36352
    v_mfma_f32_16x16x32_bf16 v[12:15], v[192:195], a[224:227], v[12:15]
    buffer_load_dwordx4 v223, s[52:55], s46 offen offset:2048 lds
    s_waitcnt lgkmcnt(11)
    v_mfma_f32_16x16x32_bf16 v[0:3], v[196:199], a[36:39], v[0:3]
    ds_read_b128 a[44:47], v222 offset:45056
    ds_read_b128 a[108:111], v222 offset:46080
    s_waitcnt lgkmcnt(12)
    v_mfma_f32_16x16x32_bf16 v[4:7], v[196:199], a[100:103], v[4:7]
    ds_read_b128 a[172:175], v222 offset:47104
    ds_read_b128 a[236:239], v222 offset:48128
    s_waitcnt lgkmcnt(13)
    v_mfma_f32_16x16x32_bf16 v[8:11], v[196:199], a[164:167], v[8:11]
    ds_read_b64_tr_b16 v[192:193], v253 offset:36864
    ds_read_b64_tr_b16 v[194:195], v253 offset:37376
    s_waitcnt lgkmcnt(14)
    v_mfma_f32_16x16x32_bf16 v[12:15], v[196:199], a[228:231], v[12:15]
    buffer_load_dwordx4 v223, s[52:55], s47 offen offset:3072 lds
    s_waitcnt lgkmcnt(11)
    v_mfma_f32_16x16x32_bf16 v[0:3], v[200:203], a[40:43], v[0:3]
    ds_read_b128 a[48:51], v222 offset:49152
    ds_read_b128 a[112:115], v222 offset:50176
    s_waitcnt lgkmcnt(12)
    v_mfma_f32_16x16x32_bf16 v[4:7], v[200:203], a[104:107], v[4:7]
    ds_read_b128 a[176:179], v222 offset:51200
    ds_read_b128 a[240:243], v222 offset:52224
    s_waitcnt lgkmcnt(13)
    v_mfma_f32_16x16x32_bf16 v[8:11], v[200:203], a[168:171], v[8:11]
    ds_read_b64_tr_b16 v[196:197], v253 offset:37888
    ds_read_b64_tr_b16 v[198:199], v253 offset:38400
    s_waitcnt lgkmcnt(14)
    v_mfma_f32_16x16x32_bf16 v[12:15], v[200:203], a[232:235], v[12:15]
    s_add_u32 m0, s89, 4096
    s_nop 0
    buffer_load_dwordx4 v223, s[52:55], s48 offen offset:0 lds
    s_waitcnt lgkmcnt(11)
    v_mfma_f32_16x16x32_bf16 v[0:3], v[204:207], a[44:47], v[0:3]
    ds_read_b128 a[52:55], v222 offset:53248
    ds_read_b128 a[116:119], v222 offset:54272
    s_waitcnt lgkmcnt(12)
    v_mfma_f32_16x16x32_bf16 v[4:7], v[204:207], a[108:111], v[4:7]
    ds_read_b128 a[180:183], v222 offset:55296
    ds_read_b128 a[244:247], v222 offset:56320
    s_waitcnt lgkmcnt(13)
    v_mfma_f32_16x16x32_bf16 v[8:11], v[204:207], a[172:175], v[8:11]
    ds_read_b64_tr_b16 v[200:201], v253 offset:38912
    ds_read_b64_tr_b16 v[202:203], v253 offset:39424
    s_waitcnt lgkmcnt(14)
    v_mfma_f32_16x16x32_bf16 v[12:15], v[204:207], a[236:239], v[12:15]
    buffer_load_dwordx4 v223, s[52:55], s49 offen offset:1024 lds
    s_waitcnt lgkmcnt(11)
    v_mfma_f32_16x16x32_bf16 v[0:3], v[192:195], a[48:51], v[0:3]
    ds_read_b128 a[56:59], v222 offset:57344
    ds_read_b128 a[120:123], v222 offset:58368
    s_waitcnt lgkmcnt(12)
    v_mfma_f32_16x16x32_bf16 v[4:7], v[192:195], a[112:115], v[4:7]
    ds_read_b128 a[184:187], v222 offset:59392
    ds_read_b128 a[248:251], v222 offset:60416
    s_waitcnt lgkmcnt(13)
    v_mfma_f32_16x16x32_bf16 v[8:11], v[192:195], a[176:179], v[8:11]
    ds_read_b64_tr_b16 v[204:205], v253 offset:39936
    ds_read_b64_tr_b16 v[206:207], v253 offset:40448
    s_waitcnt lgkmcnt(14)
    v_mfma_f32_16x16x32_bf16 v[12:15], v[192:195], a[240:243], v[12:15]
    buffer_load_dwordx4 v223, s[52:55], s50 offen offset:2048 lds
    s_waitcnt lgkmcnt(11)
    v_mfma_f32_16x16x32_bf16 v[0:3], v[196:199], a[52:55], v[0:3]
    ds_read_b128 a[60:63], v222 offset:61440
    ds_read_b128 a[124:127], v222 offset:62464
    ds_read_b128 a[188:191], v222 offset:63488
    ds_read_b128 a[252:255], v222 offset:64512
    s_waitcnt lgkmcnt(14)
    v_mfma_f32_16x16x32_bf16 v[4:7], v[196:199], a[116:119], v[4:7]
    buffer_load_dwordx4 v223, s[52:55], s51 offen offset:3072 lds
    s_add_u32 s69, s35, 2
    s_cmp_gt_u32 s69, 7
    s_cselect_b32 s93, 7, 0
    s_waitcnt lgkmcnt(13)
    v_mfma_f32_16x16x32_bf16 v[8:11], v[196:199], a[180:183], v[8:11]
    s_sub_u32 s69, s69, s93
    s_add_u32 s69, s69, s66
    s_and_b32 s69, s69, 7
    s_lshl_b32 s69, s69, 7
    s_waitcnt lgkmcnt(12)
    v_mfma_f32_16x16x32_bf16 v[12:15], v[196:199], a[244:247], v[12:15]
    v_add_u32 v223, s69, v252
    s_waitcnt lgkmcnt(4)
    s_waitcnt vmcnt(8)
    s_barrier
    v_mfma_f32_16x16x32_bf16 v[0:3], v[200:203], a[56:59], v[0:3]
    ds_read_b64_tr_b16 v[192:193], v254 offset:0
    ds_read_b64_tr_b16 v[194:195], v254 offset:512
    v_mfma_f32_16x16x32_bf16 v[4:7], v[200:203], a[120:123], v[4:7]
    ds_read_b64_tr_b16 v[196:197], v254 offset:1024
    ds_read_b64_tr_b16 v[198:199], v254 offset:1536
    v_mfma_f32_16x16x32_bf16 v[8:11], v[200:203], a[184:187], v[8:11]
    s_add_u32 m0, s89, 32768
    s_nop 0
    buffer_load_dwordx4 v223, s[52:55], 0 offen offset:0 lds
    v_mfma_f32_16x16x32_bf16 v[12:15], v[200:203], a[248:251], v[12:15]
    s_waitcnt lgkmcnt(7)
    v_mfma_f32_16x16x32_bf16 v[0:3], v[204:207], a[60:63], v[0:3]
    ds_read_b64_tr_b16 v[200:201], v254 offset:2048
    s_waitcnt lgkmcnt(7)
    v_mfma_f32_16x16x32_bf16 v[4:7], v[204:207], a[124:127], v[4:7]
    ds_read_b64_tr_b16 v[202:203], v254 offset:2560
    s_waitcnt lgkmcnt(7)
    v_mfma_f32_16x16x32_bf16 v[8:11], v[204:207], a[188:191], v[8:11]
    buffer_load_dwordx4 v223, s[52:55], s37 offen offset:1024 lds
    s_waitcnt lgkmcnt(6)
    v_mfma_f32_16x16x32_bf16 v[12:15], v[204:207], a[252:255], v[12:15]
    s_waitcnt lgkmcnt(4)
    v_mfma_f32_16x16x32_bf16 v[16:19], v[192:195], a[0:3], 0
    ds_read_b64_tr_b16 v[204:205], v254 offset:3072
    v_mfma_f32_16x16x32_bf16 v[20:23], v[192:195], a[64:67], 0
    ds_read_b64_tr_b16 v[206:207], v254 offset:3584
    v_mfma_f32_16x16x32_bf16 v[24:27], v[192:195], a[128:131], 0
    buffer_load_dwordx4 v223, s[52:55], s38 offen offset:2048 lds
    v_mfma_f32_16x16x32_bf16 v[28:31], v[192:195], a[192:195], 0
    s_waitcnt lgkmcnt(4)
    v_mfma_f32_16x16x32_bf16 v[16:19], v[196:199], a[4:7], v[16:19]
    ds_read_b64_tr_b16 v[192:193], v254 offset:4096
    v_mfma_f32_16x16x32_bf16 v[20:23], v[196:199], a[68:71], v[20:23]
    ds_read_b64_tr_b16 v[194:195], v254 offset:4608
    v_mfma_f32_16x16x32_bf16 v[24:27], v[196:199], a[132:135], v[24:27]
    buffer_load_dwordx4 v223, s[52:55], s39 offen offset:3072 lds
    v_mfma_f32_16x16x32_bf16 v[28:31], v[196:199], a[196:199], v[28:31]
    s_waitcnt lgkmcnt(4)
    v_mfma_f32_16x16x32_bf16 v[16:19], v[200:203], a[8:11], v[16:19]
    ds_read_b64_tr_b16 v[196:197], v254 offset:5120
    ds_read_b64_tr_b16 v[198:199], v254 offset:5632
    s_add_u32 m0, s89, 36864
    v_mfma_f32_16x16x32_bf16 v[20:23], v[200:203], a[72:75], v[20:23]
    buffer_load_dwordx4 v223, s[52:55], s40 offen offset:0 lds
    s_lshl1_add_u32 s71, s64, 0
    s_sub_u32 s72, s71, s66
    s_and_b32 s72, s72, 7
    s_sub_i32 s73, s72, s35
    s_cmp_le_i32 s73, 0
    s_cselect_b32 s93, 7, 0
    s_add_u32 s73, s73, s93
    s_cmp_eq_u32 s72, 0
    s_cselect_b32 s73, 0, s73
    s_lshl_b32 s73, s73, 10
    s_mul_i32 s71, s71, 73728
    s_add_u32 s73, s73, s71
    s_add_u32 s73, s73, s75
    s_lshl1_add_u32 s71, s64, 1
    s_sub_u32 s72, s71, s66
    s_and_b32 s72, s72, 7
    s_sub_i32 s74, s72, s35
    s_cmp_le_i32 s74, 0
    s_cselect_b32 s93, 7, 0
    s_add_u32 s74, s74, s93
    s_cmp_eq_u32 s72, 0
    s_cselect_b32 s74, 0, s74
    s_lshl_b32 s74, s74, 10
    s_mul_i32 s71, s71, 73728
    s_add_u32 s74, s74, s71
    s_add_u32 s74, s74, s75
    s_bitcmp1_b32 s66, 0
    s_cselect_b64 vcc, -1, 0
    v_cvt_pk_bf16_f32 v32, v0, v1
    v_mfma_f32_16x16x32_bf16 v[24:27], v[200:203], a[136:139], v[24:27]
    v_cvt_pk_bf16_f32 v33, v2, v3
    v_cvt_pk_bf16_f32 v34, v4, v5
    v_cvt_pk_bf16_f32 v35, v6, v7
    v_mfma_f32_16x16x32_bf16 v[28:31], v[200:203], a[200:203], v[28:31]
    v_cvt_pk_bf16_f32 v36, v8, v9
    v_cvt_pk_bf16_f32 v37, v10, v11
    s_waitcnt lgkmcnt(4)
    v_mfma_f32_16x16x32_bf16 v[16:19], v[204:207], a[12:15], v[16:19]
    ds_read_b64_tr_b16 v[200:201], v254 offset:6144
    ds_read_b64_tr_b16 v[202:203], v254 offset:6656
    buffer_load_dwordx4 v223, s[52:55], s41 offen offset:1024 lds
    v_mfma_f32_16x16x32_bf16 v[20:23], v[204:207], a[76:79], v[20:23]
    v_cvt_pk_bf16_f32 v38, v12, v13
    v_cvt_pk_bf16_f32 v39, v14, v15
    v_cndmask_b32 v48, v0, v8, vcc
    v_mfma_f32_16x16x32_bf16 v[24:27], v[204:207], a[140:143], v[24:27]
    v_cndmask_b32 v49, v1, v9, vcc
    v_cndmask_b32 v50, v2, v10, vcc
    v_cndmask_b32 v51, v3, v11, vcc
    v_mfma_f32_16x16x32_bf16 v[28:31], v[204:207], a[204:207], v[28:31]
    s_waitcnt lgkmcnt(4)
    v_mfma_f32_16x16x32_bf16 v[16:19], v[192:195], a[16:19], v[16:19]
    ds_read_b64_tr_b16 v[204:205], v254 offset:7168
    ds_read_b64_tr_b16 v[206:207], v254 offset:7680
    v_mfma_f32_16x16x32_bf16 v[20:23], v[192:195], a[80:83], v[20:23]
    buffer_load_dwordx4 v223, s[52:55], s42 offen offset:2048 lds
    v_cndmask_b32 v52, v4, v12, vcc
    v_mfma_f32_16x16x32_bf16 v[24:27], v[192:195], a[144:147], v[24:27]
    v_cndmask_b32 v53, v5, v13, vcc
    v_cndmask_b32 v54, v6, v14, vcc
    v_mfma_f32_16x16x32_bf16 v[28:31], v[192:195], a[208:211], v[28:31]
    v_cndmask_b32 v55, v7, v15, vcc
    s_waitcnt lgkmcnt(4)
    v_mfma_f32_16x16x32_bf16 v[16:19], v[196:199], a[20:23], v[16:19]
    buffer_load_dwordx4 v223, s[52:55], s43 offen offset:3072 lds
    v_mfma_f32_16x16x32_bf16 v[20:23], v[196:199], a[84:87], v[20:23]
    buffer_store_dwordx4 v[32:35], v255, s[60:63], s73 offen sc1
    v_mfma_f32_16x16x32_bf16 v[24:27], v[196:199], a[148:151], v[24:27]
    buffer_store_dwordx4 v[36:39], v255, s[60:63], s74 offen sc1
    v_mfma_f32_16x16x32_bf16 v[28:31], v[196:199], a[212:215], v[28:31]
    s_waitcnt lgkmcnt(0)
    s_waitcnt vmcnt(10)
    s_barrier
    v_mfma_f32_16x16x32_bf16 v[16:19], v[200:203], a[24:27], v[16:19]
    ds_read_b64_tr_b16 v[192:193], v253 offset:0
    ds_read_b64_tr_b16 v[194:195], v253 offset:512
    ds_read_b64_tr_b16 v[196:197], v253 offset:1024
    v_mfma_f32_16x16x32_bf16 v[20:23], v[200:203], a[88:91], v[20:23]
    ds_read_b64_tr_b16 v[198:199], v253 offset:1536
    s_add_u32 m0, s89, 65536
    s_nop 0
    buffer_load_dwordx4 v223, s[52:55], s44 offen offset:0 lds
    v_mfma_f32_16x16x32_bf16 v[24:27], v[200:203], a[152:155], v[24:27]
    v_mov_b32 v149, s101
    v_and_b32 v151, 7, v240
    v_lshlrev_b32 v151, 2, v151
    v_mfma_f32_16x16x32_bf16 v[28:31], v[200:203], a[216:219], v[28:31]
    v_mov_b32 v56, 0
    v_mfma_f32_16x16x32_bf16 v[16:19], v[204:207], a[28:31], v[16:19]
    ds_read_b64_tr_b16 v[200:201], v253 offset:2048
    ds_read_b64_tr_b16 v[202:203], v253 offset:2560
    v_mfma_f32_16x16x32_bf16 v[20:23], v[204:207], a[92:95], v[20:23]
    buffer_load_dwordx4 v223, s[52:55], s45 offen offset:1024 lds
    v_mov_b32 v57, 0
    v_mfma_f32_16x16x32_bf16 v[24:27], v[204:207], a[156:159], v[24:27]
    v_mov_b32 v60, 0
    v_mov_b32 v61, 0
    v_mfma_f32_16x16x32_bf16 v[28:31], v[204:207], a[220:223], v[28:31]
    v_bfe_u32 v152, v240, 2, 2
    s_waitcnt lgkmcnt(4)
    v_mfma_f32_16x16x32_bf16 v[16:19], v[192:195], a[32:35], v[16:19]
    ds_read_b64_tr_b16 v[204:205], v253 offset:3072
    ds_read_b64_tr_b16 v[206:207], v253 offset:3584
    v_mfma_f32_16x16x32_bf16 v[20:23], v[192:195], a[96:99], v[20:23]
    buffer_load_dwordx4 v223, s[52:55], s46 offen offset:2048 lds
    v_lshrrev_b32 v153, 4, v240
    v_mfma_f32_16x16x32_bf16 v[24:27], v[192:195], a[160:163], v[24:27]
    v_and_b32 v154, 1, v240
    v_lshlrev_b32 v154, 4, v154
    v_mfma_f32_16x16x32_bf16 v[28:31], v[192:195], a[224:227], v[28:31]
    v_mov_b32 v155, 0x3f80
    s_waitcnt lgkmcnt(4)
    v_mfma_f32_16x16x32_bf16 v[16:19], v[196:199], a[36:39], v[16:19]
    ds_read_b64_tr_b16 v[192:193], v253 offset:4096
    ds_read_b64_tr_b16 v[194:195], v253 offset:4608
    v_mfma_f32_16x16x32_bf16 v[20:23], v[196:199], a[100:103], v[20:23]
    buffer_load_dwordx4 v223, s[52:55], s47 offen offset:3072 lds
    v_lshlrev_b32 v154, v154, v155
    v_mfma_f32_16x16x32_bf16 v[24:27], v[196:199], a[164:167], v[24:27]
    v_cmp_eq_u32 vcc, v152, v153
    v_and_b32 v152, 2, v240
    v_mfma_f32_16x16x32_bf16 v[28:31], v[196:199], a[228:231], v[28:31]
    v_and_b32 v157, 31, v240
    s_waitcnt lgkmcnt(4)
    v_mfma_f32_16x16x32_bf16 v[16:19], v[200:203], a[40:43], v[16:19]
    ds_read_b64_tr_b16 v[196:197], v253 offset:5120
    ds_read_b64_tr_b16 v[198:199], v253 offset:5632
    v_mfma_f32_16x16x32_bf16 v[20:23], v[200:203], a[104:107], v[20:23]
    s_add_u32 m0, s89, 69632
    s_nop 0
    buffer_load_dwordx4 v223, s[52:55], s48 offen offset:0 lds
    v_mfma_f32_16x16x32_bf16 v[24:27], v[200:203], a[168:171], v[24:27]
    v_cndmask_b32 v154, 0, v154, vcc
    v_cmp_eq_u32 vcc, 0, v152
    v_mfma_f32_16x16x32_bf16 v[28:31], v[200:203], a[232:235], v[28:31]
    s_lshl_b32 s71, s67, 6
    v_add_u32 v157, s71, v157
    s_waitcnt lgkmcnt(4)
    v_mfma_f32_16x16x32_bf16 v[16:19], v[204:207], a[44:47], v[16:19]
    ds_read_b64_tr_b16 v[200:201], v253 offset:6144
    ds_read_b64_tr_b16 v[202:203], v253 offset:6656
    v_mfma_f32_16x16x32_bf16 v[20:23], v[204:207], a[108:111], v[20:23]
    buffer_load_dwordx4 v223, s[52:55], s49 offen offset:1024 lds
    v_mul_u32_u24 v157, 2304, v157
    v_mfma_f32_16x16x32_bf16 v[24:27], v[204:207], a[172:175], v[24:27]
    v_cndmask_b32 v58, 0, v154, vcc
    v_cndmask_b32 v59, v154, v56, vcc
    v_mfma_f32_16x16x32_bf16 v[28:31], v[204:207], a[236:239], v[28:31]
    v_lshrrev_b32 v153, 5, v240
    s_waitcnt lgkmcnt(4)
    v_mfma_f32_16x16x32_bf16 v[16:19], v[192:195], a[48:51], v[16:19]
    ds_read_b64_tr_b16 v[204:205], v253 offset:7168
    ds_read_b64_tr_b16 v[206:207], v253 offset:7680
    v_mfma_f32_16x16x32_bf16 v[20:23], v[192:195], a[112:115], v[20:23]
    buffer_load_dwordx4 v223, s[52:55], s50 offen offset:2048 lds
    v_lshlrev_b32 v153, 4, v153
    v_mfma_f32_16x16x32_bf16 v[24:27], v[192:195], a[176:179], v[24:27]
    s_mul_i32 s71, s65, 1152
    s_lshl_b32 s72, s64, 5
    v_mfma_f32_16x16x32_bf16 v[28:31], v[192:195], a[240:243], v[28:31]
    s_add_u32 s71, s71, s72
    s_waitcnt lgkmcnt(4)
    v_mfma_f32_16x16x32_bf16 v[16:19], v[196:199], a[52:55], v[16:19]
    buffer_load_dwordx4 v223, s[52:55], s51 offen offset:3072 lds
    s_add_u32 s69, s35, 3
    s_cmp_gt_u32 s69, 7
    v_mfma_f32_16x16x32_bf16 v[20:23], v[196:199], a[116:119], v[20:23]
    s_cselect_b32 s93, 7, 0
    s_sub_u32 s69, s69, s93
    s_add_u32 s69, s69, s66
    v_mfma_f32_16x16x32_bf16 v[24:27], v[196:199], a[180:183], v[24:27]
    s_and_b32 s69, s69, 7
    s_lshl_b32 s69, s69, 7
    v_add_u32 v223, s69, v252
    v_mfma_f32_16x16x32_bf16 v[28:31], v[196:199], a[244:247], v[28:31]
    s_add_u32 s78, s75, s34
    v_add3_u32 v156, v157, v153, s71
    s_waitcnt lgkmcnt(0)
    s_waitcnt vmcnt(10)
    s_barrier
    v_mfma_f32_16x16x32_bf16 v[16:19], v[200:203], a[56:59], v[16:19]
    ds_read_b64_tr_b16 v[192:193], v253 offset:32768
    ds_read_b64_tr_b16 v[194:195], v253 offset:33280
    v_mfma_f32_16x16x32_bf16 v[20:23], v[200:203], a[120:123], v[20:23]
    ds_read_b64_tr_b16 v[196:197], v253 offset:33792
    ds_read_b64_tr_b16 v[198:199], v253 offset:34304
    v_mfma_f32_16x16x32_bf16 v[24:27], v[200:203], a[184:187], v[24:27]
    s_add_u32 m0, s89, 0
    s_nop 0
    buffer_load_dwordx4 v223, s[52:55], 0 offen offset:0 lds
    v_mfma_f32_16x16x32_bf16 v[28:31], v[200:203], a[248:251], v[28:31]
    v_mfma_f32_16x16x32_bf16 v[16:19], v[204:207], a[60:63], v[16:19]
    ds_read_b64_tr_b16 v[200:201], v253 offset:34816
    v_mfma_f32_16x16x32_bf16 v[20:23], v[204:207], a[124:127], v[20:23]
    ds_read_b64_tr_b16 v[202:203], v253 offset:35328
    v_mfma_f32_16x16x32_bf16 v[24:27], v[204:207], a[188:191], v[24:27]
    buffer_load_dwordx4 v223, s[52:55], s37 offen offset:1024 lds
    v_mfma_f32_16x16x32_bf16 v[28:31], v[204:207], a[252:255], v[28:31]
    s_waitcnt lgkmcnt(4)
    v_mfma_f32_16x16x32_bf16 v[0:3], v[192:195], a[0:3], 0
    ds_read_b64_tr_b16 v[204:205], v253 offset:35840
    v_mfma_f32_16x16x32_bf16 v[4:7], v[192:195], a[64:67], 0
    ds_read_b64_tr_b16 v[206:207], v253 offset:36352
    v_mfma_f32_16x16x32_bf16 v[8:11], v[192:195], a[128:131], 0
    buffer_load_dwordx4 v223, s[52:55], s38 offen offset:2048 lds
    v_mfma_f32_16x16x32_bf16 v[12:15], v[192:195], a[192:195], 0
    s_waitcnt lgkmcnt(4)
    v_mfma_f32_16x16x32_bf16 v[0:3], v[196:199], a[4:7], v[0:3]
    ds_read_b64_tr_b16 v[192:193], v253 offset:36864
    v_mfma_f32_16x16x32_bf16 v[4:7], v[196:199], a[68:71], v[4:7]
    ds_read_b64_tr_b16 v[194:195], v253 offset:37376
    v_mfma_f32_16x16x32_bf16 v[8:11], v[196:199], a[132:135], v[8:11]
    buffer_load_dwordx4 v223, s[52:55], s39 offen offset:3072 lds
    v_mfma_f32_16x16x32_bf16 v[12:15], v[196:199], a[196:199], v[12:15]
    s_add_u32 s79, s35, 7
    s_cmp_gt_u32 s79, 7
    s_cselect_b32 s93, 7, 0
    s_sub_u32 s79, s79, s93
    s_add_u32 s79, s79, s66
    s_and_b32 s79, s79, 7
    s_lshl_b32 s79, s79, 7
    s_add_u32 s79, s79, s32
    s_waitcnt vmcnt(12)
    s_mov_b64 exec, 1
    buffer_store_dword v149, off, s[60:63], s79 offset:28 sc1
    s_add_u32 s79, s35, 7
    s_cmp_gt_u32 s79, 7
    s_cselect_b32 s93, 7, 0
    s_sub_u32 s79, s79, s93
    s_add_u32 s79, s79, s66
    s_and_b32 s79, s79, 7
    s_lshl_b32 s72, s66, 1
    s_sub_u32 s79, s72, s79
    s_and_b32 s79, s79, 7
    s_lshl_b32 s79, s79, 7
    s_add_u32 s79, s79, s32
    buffer_store_dword v149, off, s[60:63], s79 sc1
    s_mov_b64 exec, -1
    s_waitcnt lgkmcnt(4)
    v_mfma_f32_16x16x32_bf16 v[0:3], v[200:203], a[8:11], v[0:3]
    ds_read_b64_tr_b16 v[196:197], v253 offset:37888
    ds_read_b64_tr_b16 v[198:199], v253 offset:38400
    s_add_u32 m0, s89, 4096
    v_mfma_f32_16x16x32_bf16 v[4:7], v[200:203], a[72:75], v[4:7]
    buffer_load_dwordx4 v223, s[52:55], s40 offen offset:0 lds
    s_add_u32 s92, s35, 1
    s_cmp_gt_u32 s92, 7
    s_cselect_b32 s93, 7, 0
    s_sub_u32 s92, s92, s93
    s_add_u32 s92, s92, s66
    s_and_b32 s92, s92, 7
    s_lshl_b32 s77, s92, 7
    s_add_u32 s77, s77, s32
    s_mul_i32 s92, s92, 73728
    s_add_u32 s92, s92, 8192
    v_cvt_pk_bf16_f32 v40, v16, v17
    v_mfma_f32_16x16x32_bf16 v[8:11], v[200:203], a[136:139], v[8:11]
    v_cvt_pk_bf16_f32 v41, v18, v19
    v_cvt_pk_bf16_f32 v42, v20, v21
    v_cvt_pk_bf16_f32 v43, v22, v23
    v_mfma_f32_16x16x32_bf16 v[12:15], v[200:203], a[200:203], v[12:15]
    s_waitcnt lgkmcnt(4)
    v_mfma_f32_16x16x32_bf16 v[0:3], v[204:207], a[12:15], v[0:3]
    ds_read_b64_tr_b16 v[200:201], v253 offset:38912
    ds_read_b64_tr_b16 v[202:203], v253 offset:39424
    v_mfma_f32_16x16x32_bf16 v[4:7], v[204:207], a[76:79], v[4:7]
    buffer_load_dwordx4 v223, s[52:55], s41 offen offset:1024 lds
    v_cvt_pk_bf16_f32 v44, v24, v25
    v_mfma_f32_16x16x32_bf16 v[8:11], v[204:207], a[140:143], v[8:11]
    v_cvt_pk_bf16_f32 v45, v26, v27
    v_cvt_pk_bf16_f32 v46, v28, v29
    v_mfma_f32_16x16x32_bf16 v[12:15], v[204:207], a[204:207], v[12:15]
    v_cvt_pk_bf16_f32 v47, v30, v31
    s_waitcnt lgkmcnt(4)
    v_mfma_f32_16x16x32_bf16 v[0:3], v[192:195], a[16:19], v[0:3]
    ds_read_b64_tr_b16 v[204:205], v253 offset:39936
    v_mfma_f32_16x16x32_bf16 v[4:7], v[192:195], a[80:83], v[4:7]
    ds_read_b64_tr_b16 v[206:207], v253 offset:40448
    v_mfma_f32_16x16x32_bf16 v[8:11], v[192:195], a[144:147], v[8:11]
    buffer_load_dwordx4 v223, s[52:55], s42 offen offset:2048 lds
    v_mfma_f32_16x16x32_bf16 v[12:15], v[192:195], a[208:211], v[12:15]
    s_waitcnt lgkmcnt(4)
    v_mfma_f32_16x16x32_bf16 v[0:3], v[196:199], a[20:23], v[0:3]
    buffer_load_dwordx4 v223, s[52:55], s43 offen offset:3072 lds
    v_mfma_f32_16x16x32_bf16 v[4:7], v[196:199], a[84:87], v[4:7]
    buffer_store_dwordx4 v[40:43], v255, s[60:63], s92 offen offset:0 sc1
    v_mfma_f32_16x16x32_bf16 v[8:11], v[196:199], a[148:151], v[8:11]
    buffer_store_dwordx4 v[44:47], v255, s[60:63], s92 offen offset:1024 sc1
    v_mfma_f32_16x16x32_bf16 v[12:15], v[196:199], a[212:215], v[12:15]
    s_waitcnt lgkmcnt(0)
    s_waitcnt vmcnt(12)
    s_barrier
    v_mfma_f32_16x16x32_bf16 v[0:3], v[200:203], a[24:27], v[0:3]
    ds_read_b64_tr_b16 v[192:193], v254 offset:0
    ds_read_b64_tr_b16 v[194:195], v254 offset:512
    v_mfma_f32_16x16x32_bf16 v[4:7], v[200:203], a[88:91], v[4:7]
    ds_read_b64_tr_b16 v[196:197], v254 offset:1024
    ds_read_b64_tr_b16 v[198:199], v254 offset:1536
    v_mfma_f32_16x16x32_bf16 v[8:11], v[200:203], a[152:155], v[8:11]
    s_add_u32 m0, s89, 32768
    s_nop 0
    buffer_load_dwordx4 v223, s[52:55], s44 offen offset:0 lds
    v_mfma_f32_16x16x32_bf16 v[12:15], v[200:203], a[216:219], v[12:15]
    v_mfma_f32_16x16x32_bf16 v[0:3], v[204:207], a[28:31], v[0:3]
    ds_read_b64_tr_b16 v[200:201], v254 offset:2048
    v_mfma_f32_16x16x32_bf16 v[4:7], v[204:207], a[92:95], v[4:7]
    ds_read_b64_tr_b16 v[202:203], v254 offset:2560
    v_mfma_f32_16x16x32_bf16 v[8:11], v[204:207], a[156:159], v[8:11]
    buffer_load_dwordx4 v223, s[52:55], s45 offen offset:1024 lds
    v_mfma_f32_16x16x32_bf16 v[12:15], v[204:207], a[220:223], v[12:15]
    s_waitcnt lgkmcnt(4)
    v_mfma_f32_16x16x32_bf16 v[0:3], v[192:195], a[32:35], v[0:3]
    ds_read_b64_tr_b16 v[204:205], v254 offset:3072
    v_mfma_f32_16x16x32_bf16 v[4:7], v[192:195], a[96:99], v[4:7]
    ds_read_b64_tr_b16 v[206:207], v254 offset:3584
    v_mfma_f32_16x16x32_bf16 v[8:11], v[192:195], a[160:163], v[8:11]
    buffer_load_dwordx4 v223, s[52:55], s46 offen offset:2048 lds
    v_mfma_f32_16x16x32_bf16 v[12:15], v[192:195], a[224:227], v[12:15]
    s_waitcnt lgkmcnt(4)
    v_mfma_f32_16x16x32_bf16 v[0:3], v[196:199], a[36:39], v[0:3]
    ds_read_b64_tr_b16 v[192:193], v254 offset:4096
    v_mfma_f32_16x16x32_bf16 v[4:7], v[196:199], a[100:103], v[4:7]
    ds_read_b64_tr_b16 v[194:195], v254 offset:4608
    v_mfma_f32_16x16x32_bf16 v[8:11], v[196:199], a[164:167], v[8:11]
    buffer_load_dwordx4 v223, s[52:55], s47 offen offset:3072 lds
    v_mfma_f32_16x16x32_bf16 v[12:15], v[196:199], a[228:231], v[12:15]
    s_waitcnt lgkmcnt(4)
    v_mfma_f32_16x16x32_bf16 v[0:3], v[200:203], a[40:43], v[0:3]
    ds_read_b64_tr_b16 v[196:197], v254 offset:5120
    v_mfma_f32_16x16x32_bf16 v[4:7], v[200:203], a[104:107], v[4:7]
    ds_read_b64_tr_b16 v[198:199], v254 offset:5632
    v_mfma_f32_16x16x32_bf16 v[8:11], v[200:203], a[168:171], v[8:11]
    s_add_u32 m0, s89, 36864
    v_mfma_f32_16x16x32_bf16 v[12:15], v[200:203], a[232:235], v[12:15]
    buffer_load_dwordx4 v223, s[52:55], s48 offen offset:0 lds
    s_waitcnt lgkmcnt(4)
    v_mfma_f32_16x16x32_bf16 v[0:3], v[204:207], a[44:47], v[0:3]
    ds_read_b64_tr_b16 v[200:201], v254 offset:6144
    v_mfma_f32_16x16x32_bf16 v[4:7], v[204:207], a[108:111], v[4:7]
    ds_read_b64_tr_b16 v[202:203], v254 offset:6656
    v_mfma_f32_16x16x32_bf16 v[8:11], v[204:207], a[172:175], v[8:11]
    buffer_load_dwordx4 v223, s[52:55], s49 offen offset:1024 lds
    v_mfma_f32_16x16x32_bf16 v[12:15], v[204:207], a[236:239], v[12:15]
    s_waitcnt lgkmcnt(4)
    v_mfma_f32_16x16x32_bf16 v[0:3], v[192:195], a[48:51], v[0:3]
    ds_read_b64_tr_b16 v[204:205], v254 offset:7168
    v_mfma_f32_16x16x32_bf16 v[4:7], v[192:195], a[112:115], v[4:7]
    ds_read_b64_tr_b16 v[206:207], v254 offset:7680
    v_mfma_f32_16x16x32_bf16 v[8:11], v[192:195], a[176:179], v[8:11]
    buffer_load_dwordx4 v223, s[52:55], s50 offen offset:2048 lds
    v_mfma_f32_16x16x32_bf16 v[12:15], v[192:195], a[240:243], v[12:15]
    s_waitcnt lgkmcnt(4)
    v_mfma_f32_16x16x32_bf16 v[0:3], v[196:199], a[52:55], v[0:3]
    buffer_load_dwordx4 v223, s[52:55], s51 offen offset:3072 lds
    s_add_u32 s69, s35, 4
    s_cmp_gt_u32 s69, 7
    v_mfma_f32_16x16x32_bf16 v[4:7], v[196:199], a[116:119], v[4:7]
    s_cselect_b32 s93, 7, 0
    s_sub_u32 s69, s69, s93
    s_add_u32 s69, s69, s66
    v_mfma_f32_16x16x32_bf16 v[8:11], v[196:199], a[180:183], v[8:11]
    s_and_b32 s69, s69, 7
    s_lshl_b32 s69, s69, 7
    v_add_u32 v223, s69, v252
    v_mfma_f32_16x16x32_bf16 v[12:15], v[196:199], a[244:247], v[12:15]
    s_waitcnt lgkmcnt(0)
    s_waitcnt vmcnt(10)
    s_barrier
    v_mfma_f32_16x16x32_bf16 v[0:3], v[200:203], a[56:59], v[0:3]
    ds_read_b64_tr_b16 v[192:193], v253 offset:0
    ds_read_b64_tr_b16 v[194:195], v253 offset:512
    v_mfma_f32_16x16x32_bf16 v[4:7], v[200:203], a[120:123], v[4:7]
    ds_read_b64_tr_b16 v[196:197], v253 offset:1024
    ds_read_b64_tr_b16 v[198:199], v253 offset:1536
    v_mfma_f32_16x16x32_bf16 v[8:11], v[200:203], a[184:187], v[8:11]
    s_add_u32 m0, s89, 65536
    s_nop 0
    buffer_load_dwordx4 v223, s[52:55], 0 offen offset:0 lds
    v_mfma_f32_16x16x32_bf16 v[12:15], v[200:203], a[248:251], v[12:15]
    v_mfma_f32_16x16x32_bf16 v[0:3], v[204:207], a[60:63], v[0:3]
    ds_read_b64_tr_b16 v[200:201], v253 offset:2048
    v_mfma_f32_16x16x32_bf16 v[4:7], v[204:207], a[124:127], v[4:7]
    ds_read_b64_tr_b16 v[202:203], v253 offset:2560
    v_mfma_f32_16x16x32_bf16 v[8:11], v[204:207], a[188:191], v[8:11]
    buffer_load_dwordx4 v223, s[52:55], s37 offen offset:1024 lds
    v_mfma_f32_16x16x32_bf16 v[12:15], v[204:207], a[252:255], v[12:15]
    s_waitcnt lgkmcnt(4)
    v_mfma_f32_16x16x32_bf16 v[16:19], v[192:195], a[0:3], 0
    ds_read_b64_tr_b16 v[204:205], v253 offset:3072
    v_mfma_f32_16x16x32_bf16 v[20:23], v[192:195], a[64:67], 0
    ds_read_b64_tr_b16 v[206:207], v253 offset:3584
    v_mfma_f32_16x16x32_bf16 v[24:27], v[192:195], a[128:131], 0
    buffer_load_dwordx4 v223, s[52:55], s38 offen offset:2048 lds
    v_mfma_f32_16x16x32_bf16 v[28:31], v[192:195], a[192:195], 0
    s_waitcnt vmcnt(11)
    s_mov_b64 exec, 1
    buffer_store_dword v149, off, s[60:63], s77 offset:4 sc1
    s_mov_b64 exec, -1
    s_waitcnt lgkmcnt(4)
    v_mfma_f32_16x16x32_bf16 v[16:19], v[196:199], a[4:7], v[16:19]
    ds_read_b64_tr_b16 v[192:193], v253 offset:4096
    v_mfma_f32_16x16x32_bf16 v[20:23], v[196:199], a[68:71], v[20:23]
    ds_read_b64_tr_b16 v[194:195], v253 offset:4608
    v_mfma_f32_16x16x32_bf16 v[24:27], v[196:199], a[132:135], v[24:27]
    buffer_load_dwordx4 v223, s[52:55], s39 offen offset:3072 lds
    v_mfma_f32_16x16x32_bf16 v[28:31], v[196:199], a[196:199], v[28:31]
    s_waitcnt lgkmcnt(4)
    v_mfma_f32_16x16x32_bf16 v[16:19], v[200:203], a[8:11], v[16:19]
    ds_read_b64_tr_b16 v[196:197], v253 offset:5120
    ds_read_b64_tr_b16 v[198:199], v253 offset:5632
    s_add_u32 m0, s89, 69632
    v_mfma_f32_16x16x32_bf16 v[20:23], v[200:203], a[72:75], v[20:23]
    buffer_load_dwordx4 v223, s[52:55], s40 offen offset:0 lds
    s_add_u32 s92, s35, 2
    s_cmp_gt_u32 s92, 7
    s_cselect_b32 s93, 7, 0
    s_sub_u32 s92, s92, s93
    s_add_u32 s92, s92, s66
    s_and_b32 s92, s92, 7
    s_lshl_b32 s76, s92, 7
    s_add_u32 s76, s76, s32
    s_mul_i32 s92, s92, 73728
    s_add_u32 s92, s92, 16384
    v_cvt_pk_bf16_f32 v32, v0, v1
    v_mfma_f32_16x16x32_bf16 v[24:27], v[200:203], a[136:139], v[24:27]
    v_cvt_pk_bf16_f32 v33, v2, v3
    v_cvt_pk_bf16_f32 v34, v4, v5
    v_cvt_pk_bf16_f32 v35, v6, v7
    v_mfma_f32_16x16x32_bf16 v[28:31], v[200:203], a[200:203], v[28:31]
    s_waitcnt lgkmcnt(4)
    v_mfma_f32_16x16x32_bf16 v[16:19], v[204:207], a[12:15], v[16:19]
    ds_read_b64_tr_b16 v[200:201], v253 offset:6144
    ds_read_b64_tr_b16 v[202:203], v253 offset:6656
    v_mfma_f32_16x16x32_bf16 v[20:23], v[204:207], a[76:79], v[20:23]
    buffer_load_dwordx4 v223, s[52:55], s41 offen offset:1024 lds
    v_cvt_pk_bf16_f32 v36, v8, v9
    v_mfma_f32_16x16x32_bf16 v[24:27], v[204:207], a[140:143], v[24:27]
    v_cvt_pk_bf16_f32 v37, v10, v11
    v_cvt_pk_bf16_f32 v38, v12, v13
    v_mfma_f32_16x16x32_bf16 v[28:31], v[204:207], a[204:207], v[28:31]
    v_cvt_pk_bf16_f32 v39, v14, v15
    s_waitcnt lgkmcnt(4)
    v_mfma_f32_16x16x32_bf16 v[16:19], v[192:195], a[16:19], v[16:19]
    ds_read_b64_tr_b16 v[204:205], v253 offset:7168
    v_mfma_f32_16x16x32_bf16 v[20:23], v[192:195], a[80:83], v[20:23]
    ds_read_b64_tr_b16 v[206:207], v253 offset:7680
    v_mfma_f32_16x16x32_bf16 v[24:27], v[192:195], a[144:147], v[24:27]
    buffer_load_dwordx4 v223, s[52:55], s42 offen offset:2048 lds
    v_mfma_f32_16x16x32_bf16 v[28:31], v[192:195], a[208:211], v[28:31]
    s_waitcnt lgkmcnt(4)
    v_mfma_f32_16x16x32_bf16 v[16:19], v[196:199], a[20:23], v[16:19]
    buffer_load_dwordx4 v223, s[52:55], s43 offen offset:3072 lds
    v_mfma_f32_16x16x32_bf16 v[20:23], v[196:199], a[84:87], v[20:23]
    buffer_store_dwordx4 v[32:35], v255, s[60:63], s92 offen offset:0 sc1
    v_mfma_f32_16x16x32_bf16 v[24:27], v[196:199], a[148:151], v[24:27]
    buffer_store_dwordx4 v[36:39], v255, s[60:63], s92 offen offset:1024 sc1
    v_mfma_f32_16x16x32_bf16 v[28:31], v[196:199], a[212:215], v[28:31]
    s_waitcnt lgkmcnt(0)
    s_waitcnt vmcnt(11)
    s_barrier
    v_mfma_f32_16x16x32_bf16 v[16:19], v[200:203], a[24:27], v[16:19]
    ds_read_b64_tr_b16 v[192:193], v253 offset:32768
    ds_read_b64_tr_b16 v[194:195], v253 offset:33280
    v_mfma_f32_16x16x32_bf16 v[20:23], v[200:203], a[88:91], v[20:23]
    ds_read_b64_tr_b16 v[196:197], v253 offset:33792
    ds_read_b64_tr_b16 v[198:199], v253 offset:34304
    v_mfma_f32_16x16x32_bf16 v[24:27], v[200:203], a[152:155], v[24:27]
    s_add_u32 m0, s89, 0
    s_nop 0
    buffer_load_dwordx4 v223, s[52:55], s44 offen offset:0 lds
    v_mfma_f32_16x16x32_bf16 v[28:31], v[200:203], a[216:219], v[28:31]
    v_mfma_f32_16x16x32_bf16 v[16:19], v[204:207], a[28:31], v[16:19]
    ds_read_b64_tr_b16 v[200:201], v253 offset:34816
    v_mfma_f32_16x16x32_bf16 v[20:23], v[204:207], a[92:95], v[20:23]
    ds_read_b64_tr_b16 v[202:203], v253 offset:35328
    v_mfma_f32_16x16x32_bf16 v[24:27], v[204:207], a[156:159], v[24:27]
    buffer_load_dwordx4 v223, s[52:55], s45 offen offset:1024 lds
    v_mfma_f32_16x16x32_bf16 v[28:31], v[204:207], a[220:223], v[28:31]
    s_waitcnt lgkmcnt(4)
    v_mfma_f32_16x16x32_bf16 v[16:19], v[192:195], a[32:35], v[16:19]
    ds_read_b64_tr_b16 v[204:205], v253 offset:35840
    v_mfma_f32_16x16x32_bf16 v[20:23], v[192:195], a[96:99], v[20:23]
    ds_read_b64_tr_b16 v[206:207], v253 offset:36352
    v_mfma_f32_16x16x32_bf16 v[24:27], v[192:195], a[160:163], v[24:27]
    buffer_load_dwordx4 v223, s[52:55], s46 offen offset:2048 lds
    v_mfma_f32_16x16x32_bf16 v[28:31], v[192:195], a[224:227], v[28:31]
    s_waitcnt lgkmcnt(4)
    v_mfma_f32_16x16x32_bf16 v[16:19], v[196:199], a[36:39], v[16:19]
    ds_read_b64_tr_b16 v[192:193], v253 offset:36864
    v_mfma_f32_16x16x32_bf16 v[20:23], v[196:199], a[100:103], v[20:23]
    ds_read_b64_tr_b16 v[194:195], v253 offset:37376
    v_mfma_f32_16x16x32_bf16 v[24:27], v[196:199], a[164:167], v[24:27]
    buffer_load_dwordx4 v223, s[52:55], s47 offen offset:3072 lds
    v_mfma_f32_16x16x32_bf16 v[28:31], v[196:199], a[228:231], v[28:31]
    s_waitcnt lgkmcnt(4)
    v_mfma_f32_16x16x32_bf16 v[16:19], v[200:203], a[40:43], v[16:19]
    ds_read_b64_tr_b16 v[196:197], v253 offset:37888
    v_mfma_f32_16x16x32_bf16 v[20:23], v[200:203], a[104:107], v[20:23]
    ds_read_b64_tr_b16 v[198:199], v253 offset:38400
    v_mfma_f32_16x16x32_bf16 v[24:27], v[200:203], a[168:171], v[24:27]
    s_add_u32 m0, s89, 4096
    v_mfma_f32_16x16x32_bf16 v[28:31], v[200:203], a[232:235], v[28:31]
    buffer_load_dwordx4 v223, s[52:55], s48 offen offset:0 lds
    s_waitcnt lgkmcnt(4)
    v_mfma_f32_16x16x32_bf16 v[16:19], v[204:207], a[44:47], v[16:19]
    ds_read_b64_tr_b16 v[200:201], v253 offset:38912
    v_mfma_f32_16x16x32_bf16 v[20:23], v[204:207], a[108:111], v[20:23]
    ds_read_b64_tr_b16 v[202:203], v253 offset:39424
    v_mfma_f32_16x16x32_bf16 v[24:27], v[204:207], a[172:175], v[24:27]
    buffer_load_dwordx4 v223, s[52:55], s49 offen offset:1024 lds
    v_mfma_f32_16x16x32_bf16 v[28:31], v[204:207], a[236:239], v[28:31]
    s_waitcnt lgkmcnt(4)
    v_mfma_f32_16x16x32_bf16 v[16:19], v[192:195], a[48:51], v[16:19]
    ds_read_b64_tr_b16 v[204:205], v253 offset:39936
    v_mfma_f32_16x16x32_bf16 v[20:23], v[192:195], a[112:115], v[20:23]
    ds_read_b64_tr_b16 v[206:207], v253 offset:40448
    v_mfma_f32_16x16x32_bf16 v[24:27], v[192:195], a[176:179], v[24:27]
    buffer_load_dwordx4 v223, s[52:55], s50 offen offset:2048 lds
    v_mfma_f32_16x16x32_bf16 v[28:31], v[192:195], a[240:243], v[28:31]
    s_waitcnt lgkmcnt(4)
    v_mfma_f32_16x16x32_bf16 v[16:19], v[196:199], a[52:55], v[16:19]
    buffer_load_dwordx4 v223, s[52:55], s51 offen offset:3072 lds
    s_add_u32 s69, s35, 5
    s_cmp_gt_u32 s69, 7
    v_mfma_f32_16x16x32_bf16 v[20:23], v[196:199], a[116:119], v[20:23]
    s_cselect_b32 s93, 7, 0
    s_sub_u32 s69, s69, s93
    s_add_u32 s69, s69, s66
    v_mfma_f32_16x16x32_bf16 v[24:27], v[196:199], a[180:183], v[24:27]
    s_and_b32 s69, s69, 7
    s_lshl_b32 s69, s69, 7
    v_add_u32 v223, s69, v252
    v_mfma_f32_16x16x32_bf16 v[28:31], v[196:199], a[244:247], v[28:31]
    s_waitcnt lgkmcnt(0)
    s_waitcnt vmcnt(10)
    s_barrier
    v_mfma_f32_16x16x32_bf16 v[16:19], v[200:203], a[56:59], v[16:19]
    ds_read_b64_tr_b16 v[192:193], v254 offset:0
    ds_read_b64_tr_b16 v[194:195], v254 offset:512
    v_mfma_f32_16x16x32_bf16 v[20:23], v[200:203], a[120:123], v[20:23]
    ds_read_b64_tr_b16 v[196:197], v254 offset:1024
    ds_read_b64_tr_b16 v[198:199], v254 offset:1536
    v_mfma_f32_16x16x32_bf16 v[24:27], v[200:203], a[184:187], v[24:27]
    s_add_u32 m0, s89, 32768
    s_nop 0
    buffer_load_dwordx4 v223, s[52:55], 0 offen offset:0 lds
    v_mfma_f32_16x16x32_bf16 v[28:31], v[200:203], a[248:251], v[28:31]
    v_mfma_f32_16x16x32_bf16 v[16:19], v[204:207], a[60:63], v[16:19]
    ds_read_b64_tr_b16 v[200:201], v254 offset:2048
    v_mfma_f32_16x16x32_bf16 v[20:23], v[204:207], a[124:127], v[20:23]
    ds_read_b64_tr_b16 v[202:203], v254 offset:2560
    v_mfma_f32_16x16x32_bf16 v[24:27], v[204:207], a[188:191], v[24:27]
    buffer_load_dwordx4 v223, s[52:55], s37 offen offset:1024 lds
    v_mfma_f32_16x16x32_bf16 v[28:31], v[204:207], a[252:255], v[28:31]
    s_waitcnt lgkmcnt(4)
    v_mfma_f32_16x16x32_bf16 v[0:3], v[192:195], a[0:3], 0
    ds_read_b64_tr_b16 v[204:205], v254 offset:3072
    v_mfma_f32_16x16x32_bf16 v[4:7], v[192:195], a[64:67], 0
    ds_read_b64_tr_b16 v[206:207], v254 offset:3584
    v_mfma_f32_16x16x32_bf16 v[8:11], v[192:195], a[128:131], 0
    buffer_load_dwordx4 v223, s[52:55], s38 offen offset:2048 lds
    v_mfma_f32_16x16x32_bf16 v[12:15], v[192:195], a[192:195], 0
    s_waitcnt vmcnt(11)
    s_mov_b64 exec, 1
    buffer_store_dword v149, off, s[60:63], s76 offset:8 sc1
    s_mov_b64 exec, -1
    s_waitcnt lgkmcnt(4)
    v_mfma_f32_16x16x32_bf16 v[0:3], v[196:199], a[4:7], v[0:3]
    ds_read_b64_tr_b16 v[192:193], v254 offset:4096
    v_mfma_f32_16x16x32_bf16 v[4:7], v[196:199], a[68:71], v[4:7]
    ds_read_b64_tr_b16 v[194:195], v254 offset:4608
    v_mfma_f32_16x16x32_bf16 v[8:11], v[196:199], a[132:135], v[8:11]
    buffer_load_dwordx4 v223, s[52:55], s39 offen offset:3072 lds
    v_mfma_f32_16x16x32_bf16 v[12:15], v[196:199], a[196:199], v[12:15]
    s_waitcnt lgkmcnt(4)
    v_mfma_f32_16x16x32_bf16 v[0:3], v[200:203], a[8:11], v[0:3]
    ds_read_b64_tr_b16 v[196:197], v254 offset:5120
    ds_read_b64_tr_b16 v[198:199], v254 offset:5632
    s_add_u32 m0, s89, 36864
    v_mfma_f32_16x16x32_bf16 v[4:7], v[200:203], a[72:75], v[4:7]
    buffer_load_dwordx4 v223, s[52:55], s40 offen offset:0 lds
    s_add_u32 s92, s35, 3
    s_cmp_gt_u32 s92, 7
    s_cselect_b32 s93, 7, 0
    s_sub_u32 s92, s92, s93
    s_add_u32 s92, s92, s66
    s_and_b32 s92, s92, 7
    s_lshl_b32 s77, s92, 7
    s_add_u32 s77, s77, s32
    s_mul_i32 s92, s92, 73728
    s_add_u32 s92, s92, 24576
    v_cvt_pk_bf16_f32 v40, v16, v17
    v_mfma_f32_16x16x32_bf16 v[8:11], v[200:203], a[136:139], v[8:11]
    v_cvt_pk_bf16_f32 v41, v18, v19
    v_cvt_pk_bf16_f32 v42, v20, v21
    v_cvt_pk_bf16_f32 v43, v22, v23
    v_mfma_f32_16x16x32_bf16 v[12:15], v[200:203], a[200:203], v[12:15]
    s_waitcnt lgkmcnt(4)
    v_mfma_f32_16x16x32_bf16 v[0:3], v[204:207], a[12:15], v[0:3]
    ds_read_b64_tr_b16 v[200:201], v254 offset:6144
    ds_read_b64_tr_b16 v[202:203], v254 offset:6656
    v_mfma_f32_16x16x32_bf16 v[4:7], v[204:207], a[76:79], v[4:7]
    buffer_load_dwordx4 v223, s[52:55], s41 offen offset:1024 lds
    v_cvt_pk_bf16_f32 v44, v24, v25
    v_mfma_f32_16x16x32_bf16 v[8:11], v[204:207], a[140:143], v[8:11]
    v_cvt_pk_bf16_f32 v45, v26, v27
    v_cvt_pk_bf16_f32 v46, v28, v29
    v_mfma_f32_16x16x32_bf16 v[12:15], v[204:207], a[204:207], v[12:15]
    v_cvt_pk_bf16_f32 v47, v30, v31
    s_waitcnt lgkmcnt(4)
    v_mfma_f32_16x16x32_bf16 v[0:3], v[192:195], a[16:19], v[0:3]
    ds_read_b64_tr_b16 v[204:205], v254 offset:7168
    v_mfma_f32_16x16x32_bf16 v[4:7], v[192:195], a[80:83], v[4:7]
    ds_read_b64_tr_b16 v[206:207], v254 offset:7680
    v_mfma_f32_16x16x32_bf16 v[8:11], v[192:195], a[144:147], v[8:11]
    buffer_load_dwordx4 v223, s[52:55], s42 offen offset:2048 lds
    v_mfma_f32_16x16x32_bf16 v[12:15], v[192:195], a[208:211], v[12:15]
    s_waitcnt lgkmcnt(4)
    v_mfma_f32_16x16x32_bf16 v[0:3], v[196:199], a[20:23], v[0:3]
    buffer_load_dwordx4 v223, s[52:55], s43 offen offset:3072 lds
    v_mfma_f32_16x16x32_bf16 v[4:7], v[196:199], a[84:87], v[4:7]
    buffer_store_dwordx4 v[40:43], v255, s[60:63], s92 offen offset:0 sc1
    v_mfma_f32_16x16x32_bf16 v[8:11], v[196:199], a[148:151], v[8:11]
    buffer_store_dwordx4 v[44:47], v255, s[60:63], s92 offen offset:1024 sc1
    v_mfma_f32_16x16x32_bf16 v[12:15], v[196:199], a[212:215], v[12:15]
    s_waitcnt lgkmcnt(0)
    s_waitcnt vmcnt(11)
    s_barrier
    v_mfma_f32_16x16x32_bf16 v[0:3], v[200:203], a[24:27], v[0:3]
    ds_read_b64_tr_b16 v[192:193], v253 offset:0
    ds_read_b64_tr_b16 v[194:195], v253 offset:512
    v_mfma_f32_16x16x32_bf16 v[4:7], v[200:203], a[88:91], v[4:7]
    ds_read_b64_tr_b16 v[196:197], v253 offset:1024
    ds_read_b64_tr_b16 v[198:199], v253 offset:1536
    v_mfma_f32_16x16x32_bf16 v[8:11], v[200:203], a[152:155], v[8:11]
    s_add_u32 m0, s89, 65536
    s_nop 0
    buffer_load_dwordx4 v223, s[52:55], s44 offen offset:0 lds
    v_mfma_f32_16x16x32_bf16 v[12:15], v[200:203], a[216:219], v[12:15]
    v_mfma_f32_16x16x32_bf16 v[0:3], v[204:207], a[28:31], v[0:3]
    ds_read_b64_tr_b16 v[200:201], v253 offset:2048
    v_mfma_f32_16x16x32_bf16 v[4:7], v[204:207], a[92:95], v[4:7]
    ds_read_b64_tr_b16 v[202:203], v253 offset:2560
    v_mfma_f32_16x16x32_bf16 v[8:11], v[204:207], a[156:159], v[8:11]
    buffer_load_dwordx4 v223, s[52:55], s45 offen offset:1024 lds
    v_mfma_f32_16x16x32_bf16 v[12:15], v[204:207], a[220:223], v[12:15]
    s_waitcnt lgkmcnt(4)
    v_mfma_f32_16x16x32_bf16 v[0:3], v[192:195], a[32:35], v[0:3]
    ds_read_b64_tr_b16 v[204:205], v253 offset:3072
    v_mfma_f32_16x16x32_bf16 v[4:7], v[192:195], a[96:99], v[4:7]
    ds_read_b64_tr_b16 v[206:207], v253 offset:3584
    v_mfma_f32_16x16x32_bf16 v[8:11], v[192:195], a[160:163], v[8:11]
    buffer_load_dwordx4 v223, s[52:55], s46 offen offset:2048 lds
    v_mfma_f32_16x16x32_bf16 v[12:15], v[192:195], a[224:227], v[12:15]
    s_waitcnt lgkmcnt(4)
    v_mfma_f32_16x16x32_bf16 v[0:3], v[196:199], a[36:39], v[0:3]
    ds_read_b64_tr_b16 v[192:193], v253 offset:4096
    v_mfma_f32_16x16x32_bf16 v[4:7], v[196:199], a[100:103], v[4:7]
    ds_read_b64_tr_b16 v[194:195], v253 offset:4608
    v_mfma_f32_16x16x32_bf16 v[8:11], v[196:199], a[164:167], v[8:11]
    buffer_load_dwordx4 v223, s[52:55], s47 offen offset:3072 lds
    v_mfma_f32_16x16x32_bf16 v[12:15], v[196:199], a[228:231], v[12:15]
    s_waitcnt lgkmcnt(4)
    v_mfma_f32_16x16x32_bf16 v[0:3], v[200:203], a[40:43], v[0:3]
    ds_read_b64_tr_b16 v[196:197], v253 offset:5120
    v_mfma_f32_16x16x32_bf16 v[4:7], v[200:203], a[104:107], v[4:7]
    ds_read_b64_tr_b16 v[198:199], v253 offset:5632
    v_mfma_f32_16x16x32_bf16 v[8:11], v[200:203], a[168:171], v[8:11]
    s_add_u32 m0, s89, 69632
    v_mfma_f32_16x16x32_bf16 v[12:15], v[200:203], a[232:235], v[12:15]
    buffer_load_dwordx4 v223, s[52:55], s48 offen offset:0 lds
    s_waitcnt lgkmcnt(4)
    v_mfma_f32_16x16x32_bf16 v[0:3], v[204:207], a[44:47], v[0:3]
    ds_read_b64_tr_b16 v[200:201], v253 offset:6144
    v_mfma_f32_16x16x32_bf16 v[4:7], v[204:207], a[108:111], v[4:7]
    ds_read_b64_tr_b16 v[202:203], v253 offset:6656
    v_mfma_f32_16x16x32_bf16 v[8:11], v[204:207], a[172:175], v[8:11]
    buffer_load_dwordx4 v223, s[52:55], s49 offen offset:1024 lds
    v_mfma_f32_16x16x32_bf16 v[12:15], v[204:207], a[236:239], v[12:15]
    s_waitcnt lgkmcnt(4)
    v_mfma_f32_16x16x32_bf16 v[0:3], v[192:195], a[48:51], v[0:3]
    ds_read_b64_tr_b16 v[204:205], v253 offset:7168
    v_mfma_f32_16x16x32_bf16 v[4:7], v[192:195], a[112:115], v[4:7]
    ds_read_b64_tr_b16 v[206:207], v253 offset:7680
    v_mfma_f32_16x16x32_bf16 v[8:11], v[192:195], a[176:179], v[8:11]
    buffer_load_dwordx4 v223, s[52:55], s50 offen offset:2048 lds
    v_mfma_f32_16x16x32_bf16 v[12:15], v[192:195], a[240:243], v[12:15]
    s_waitcnt lgkmcnt(4)
    v_mfma_f32_16x16x32_bf16 v[0:3], v[196:199], a[52:55], v[0:3]
    buffer_load_dwordx4 v223, s[52:55], s51 offen offset:3072 lds
    s_add_u32 s69, s35, 6
    s_cmp_gt_u32 s69, 7
    v_mfma_f32_16x16x32_bf16 v[4:7], v[196:199], a[116:119], v[4:7]
    s_cselect_b32 s93, 7, 0
    s_sub_u32 s69, s69, s93
    s_add_u32 s69, s69, s66
    v_mfma_f32_16x16x32_bf16 v[8:11], v[196:199], a[180:183], v[8:11]
    s_and_b32 s69, s69, 7
    s_lshl_b32 s69, s69, 7
    v_add_u32 v223, s69, v252
    v_mfma_f32_16x16x32_bf16 v[12:15], v[196:199], a[244:247], v[12:15]
    s_waitcnt lgkmcnt(0)
    s_waitcnt vmcnt(10)
    s_barrier
    v_mfma_f32_16x16x32_bf16 v[0:3], v[200:203], a[56:59], v[0:3]
    ds_read_b64_tr_b16 v[192:193], v253 offset:32768
    ds_read_b64_tr_b16 v[194:195], v253 offset:33280
    v_mfma_f32_16x16x32_bf16 v[4:7], v[200:203], a[120:123], v[4:7]
    ds_read_b64_tr_b16 v[196:197], v253 offset:33792
    ds_read_b64_tr_b16 v[198:199], v253 offset:34304
    v_mfma_f32_16x16x32_bf16 v[8:11], v[200:203], a[184:187], v[8:11]
    s_add_u32 m0, s89, 0
    s_nop 0
    buffer_load_dwordx4 v223, s[52:55], 0 offen offset:0 lds
    v_mfma_f32_16x16x32_bf16 v[12:15], v[200:203], a[248:251], v[12:15]
    v_mfma_f32_16x16x32_bf16 v[0:3], v[204:207], a[60:63], v[0:3]
    ds_read_b64_tr_b16 v[200:201], v253 offset:34816
    v_mfma_f32_16x16x32_bf16 v[4:7], v[204:207], a[124:127], v[4:7]
    ds_read_b64_tr_b16 v[202:203], v253 offset:35328
    v_mfma_f32_16x16x32_bf16 v[8:11], v[204:207], a[188:191], v[8:11]
    buffer_load_dwordx4 v223, s[52:55], s37 offen offset:1024 lds
    v_mfma_f32_16x16x32_bf16 v[12:15], v[204:207], a[252:255], v[12:15]
    s_waitcnt lgkmcnt(4)
    v_mfma_f32_16x16x32_bf16 v[16:19], v[192:195], a[0:3], 0
    ds_read_b64_tr_b16 v[204:205], v253 offset:35840
    v_mfma_f32_16x16x32_bf16 v[20:23], v[192:195], a[64:67], 0
    ds_read_b64_tr_b16 v[206:207], v253 offset:36352
    v_mfma_f32_16x16x32_bf16 v[24:27], v[192:195], a[128:131], 0
    buffer_load_dwordx4 v223, s[52:55], s38 offen offset:2048 lds
    v_mfma_f32_16x16x32_bf16 v[28:31], v[192:195], a[192:195], 0
    s_waitcnt vmcnt(11)
    s_mov_b64 exec, 1
    buffer_store_dword v149, off, s[60:63], s77 offset:12 sc1
    s_mov_b64 exec, -1
    s_waitcnt lgkmcnt(4)
    v_mfma_f32_16x16x32_bf16 v[16:19], v[196:199], a[4:7], v[16:19]
    ds_read_b64_tr_b16 v[192:193], v253 offset:36864
    v_mfma_f32_16x16x32_bf16 v[20:23], v[196:199], a[68:71], v[20:23]
    ds_read_b64_tr_b16 v[194:195], v253 offset:37376
    v_mfma_f32_16x16x32_bf16 v[24:27], v[196:199], a[132:135], v[24:27]
    buffer_load_dwordx4 v223, s[52:55], s39 offen offset:3072 lds
    v_mfma_f32_16x16x32_bf16 v[28:31], v[196:199], a[196:199], v[28:31]
    s_waitcnt lgkmcnt(4)
    v_mfma_f32_16x16x32_bf16 v[16:19], v[200:203], a[8:11], v[16:19]
    ds_read_b64_tr_b16 v[196:197], v253 offset:37888
    ds_read_b64_tr_b16 v[198:199], v253 offset:38400
    s_add_u32 m0, s89, 4096
    v_mfma_f32_16x16x32_bf16 v[20:23], v[200:203], a[72:75], v[20:23]
    buffer_load_dwordx4 v223, s[52:55], s40 offen offset:0 lds
    s_add_u32 s92, s35, 4
    s_cmp_gt_u32 s92, 7
    s_cselect_b32 s93, 7, 0
    s_sub_u32 s92, s92, s93
    s_add_u32 s92, s92, s66
    s_and_b32 s92, s92, 7
    s_lshl_b32 s76, s92, 7
    s_add_u32 s76, s76, s32
    s_mul_i32 s92, s92, 73728
    s_add_u32 s92, s92, 32768
    v_cvt_pk_bf16_f32 v32, v0, v1
    v_mfma_f32_16x16x32_bf16 v[24:27], v[200:203], a[136:139], v[24:27]
    v_cvt_pk_bf16_f32 v33, v2, v3
    v_cvt_pk_bf16_f32 v34, v4, v5
    v_cvt_pk_bf16_f32 v35, v6, v7
    v_mfma_f32_16x16x32_bf16 v[28:31], v[200:203], a[200:203], v[28:31]
    s_waitcnt lgkmcnt(4)
    v_mfma_f32_16x16x32_bf16 v[16:19], v[204:207], a[12:15], v[16:19]
    ds_read_b64_tr_b16 v[200:201], v253 offset:38912
    ds_read_b64_tr_b16 v[202:203], v253 offset:39424
    v_mfma_f32_16x16x32_bf16 v[20:23], v[204:207], a[76:79], v[20:23]
    buffer_load_dwordx4 v223, s[52:55], s41 offen offset:1024 lds
    v_cvt_pk_bf16_f32 v36, v8, v9
    v_mfma_f32_16x16x32_bf16 v[24:27], v[204:207], a[140:143], v[24:27]
    v_cvt_pk_bf16_f32 v37, v10, v11
    v_cvt_pk_bf16_f32 v38, v12, v13
    v_mfma_f32_16x16x32_bf16 v[28:31], v[204:207], a[204:207], v[28:31]
    v_cvt_pk_bf16_f32 v39, v14, v15
    s_waitcnt lgkmcnt(4)
    v_mfma_f32_16x16x32_bf16 v[16:19], v[192:195], a[16:19], v[16:19]
    ds_read_b64_tr_b16 v[204:205], v253 offset:39936
    v_mfma_f32_16x16x32_bf16 v[20:23], v[192:195], a[80:83], v[20:23]
    ds_read_b64_tr_b16 v[206:207], v253 offset:40448
    v_mfma_f32_16x16x32_bf16 v[24:27], v[192:195], a[144:147], v[24:27]
    buffer_load_dwordx4 v223, s[52:55], s42 offen offset:2048 lds
    v_mfma_f32_16x16x32_bf16 v[28:31], v[192:195], a[208:211], v[28:31]
    s_waitcnt lgkmcnt(4)
    v_mfma_f32_16x16x32_bf16 v[16:19], v[196:199], a[20:23], v[16:19]
    buffer_load_dwordx4 v223, s[52:55], s43 offen offset:3072 lds
    v_mfma_f32_16x16x32_bf16 v[20:23], v[196:199], a[84:87], v[20:23]
    buffer_store_dwordx4 v[32:35], v255, s[60:63], s92 offen offset:0 sc1
    v_mfma_f32_16x16x32_bf16 v[24:27], v[196:199], a[148:151], v[24:27]
    buffer_store_dwordx4 v[36:39], v255, s[60:63], s92 offen offset:1024 sc1
    v_mfma_f32_16x16x32_bf16 v[28:31], v[196:199], a[212:215], v[28:31]
    s_waitcnt lgkmcnt(0)
    s_waitcnt vmcnt(11)
    s_barrier
    v_mfma_f32_16x16x32_bf16 v[16:19], v[200:203], a[24:27], v[16:19]
    ds_read_b64_tr_b16 v[192:193], v254 offset:0
    ds_read_b64_tr_b16 v[194:195], v254 offset:512
    v_mfma_f32_16x16x32_bf16 v[20:23], v[200:203], a[88:91], v[20:23]
    ds_read_b64_tr_b16 v[196:197], v254 offset:1024
    ds_read_b64_tr_b16 v[198:199], v254 offset:1536
    v_mfma_f32_16x16x32_bf16 v[24:27], v[200:203], a[152:155], v[24:27]
    s_add_u32 m0, s89, 32768
    s_nop 0
    buffer_load_dwordx4 v223, s[52:55], s44 offen offset:0 lds
    v_mfma_f32_16x16x32_bf16 v[28:31], v[200:203], a[216:219], v[28:31]
    s_cmp_eq_u32 s100, 0
    s_cbranch_scc0 L_e12
    s_load_dwordx8 s[80:87], s[60:61], s33 glc
L_e12:
    v_mfma_f32_16x16x32_bf16 v[16:19], v[204:207], a[28:31], v[16:19]
    ds_read_b64_tr_b16 v[200:201], v254 offset:2048
    v_mfma_f32_16x16x32_bf16 v[20:23], v[204:207], a[92:95], v[20:23]
    ds_read_b64_tr_b16 v[202:203], v254 offset:2560
    v_mfma_f32_16x16x32_bf16 v[24:27], v[204:207], a[156:159], v[24:27]
    buffer_load_dwordx4 v223, s[52:55], s45 offen offset:1024 lds
    v_mfma_f32_16x16x32_bf16 v[28:31], v[204:207], a[220:223], v[28:31]
    s_waitcnt lgkmcnt(4)
    v_mfma_f32_16x16x32_bf16 v[16:19], v[192:195], a[32:35], v[16:19]
    ds_read_b64_tr_b16 v[204:205], v254 offset:3072
    v_mfma_f32_16x16x32_bf16 v[20:23], v[192:195], a[96:99], v[20:23]
    ds_read_b64_tr_b16 v[206:207], v254 offset:3584
    v_mfma_f32_16x16x32_bf16 v[24:27], v[192:195], a[160:163], v[24:27]
    buffer_load_dwordx4 v223, s[52:55], s46 offen offset:2048 lds
    v_mfma_f32_16x16x32_bf16 v[28:31], v[192:195], a[224:227], v[28:31]
    s_waitcnt lgkmcnt(4)
    v_mfma_f32_16x16x32_bf16 v[16:19], v[196:199], a[36:39], v[16:19]
    ds_read_b64_tr_b16 v[192:193], v254 offset:4096
    v_mfma_f32_16x16x32_bf16 v[20:23], v[196:199], a[100:103], v[20:23]
    ds_read_b64_tr_b16 v[194:195], v254 offset:4608
    v_mfma_f32_16x16x32_bf16 v[24:27], v[196:199], a[164:167], v[24:27]
    buffer_load_dwordx4 v223, s[52:55], s47 offen offset:3072 lds
    v_mfma_f32_16x16x32_bf16 v[28:31], v[196:199], a[228:231], v[28:31]
    s_waitcnt lgkmcnt(4)
    v_mfma_f32_16x16x32_bf16 v[16:19], v[200:203], a[40:43], v[16:19]
    ds_read_b64_tr_b16 v[196:197], v254 offset:5120
    v_mfma_f32_16x16x32_bf16 v[20:23], v[200:203], a[104:107], v[20:23]
    ds_read_b64_tr_b16 v[198:199], v254 offset:5632
    v_mfma_f32_16x16x32_bf16 v[24:27], v[200:203], a[168:171], v[24:27]
    s_add_u32 m0, s89, 36864
    v_mfma_f32_16x16x32_bf16 v[28:31], v[200:203], a[232:235], v[28:31]
    buffer_load_dwordx4 v223, s[52:55], s48 offen offset:0 lds
    s_waitcnt lgkmcnt(4)
    v_mfma_f32_16x16x32_bf16 v[16:19], v[204:207], a[44:47], v[16:19]
    ds_read_b64_tr_b16 v[200:201], v254 offset:6144
    v_mfma_f32_16x16x32_bf16 v[20:23], v[204:207], a[108:111], v[20:23]
    ds_read_b64_tr_b16 v[202:203], v254 offset:6656
    v_mfma_f32_16x16x32_bf16 v[24:27], v[204:207], a[172:175], v[24:27]
    buffer_load_dwordx4 v223, s[52:55], s49 offen offset:1024 lds
    v_mfma_f32_16x16x32_bf16 v[28:31], v[204:207], a[236:239], v[28:31]
    s_waitcnt lgkmcnt(4)
    v_mfma_f32_16x16x32_bf16 v[16:19], v[192:195], a[48:51], v[16:19]
    ds_read_b64_tr_b16 v[204:205], v254 offset:7168
    v_mfma_f32_16x16x32_bf16 v[20:23], v[192:195], a[112:115], v[20:23]
    ds_read_b64_tr_b16 v[206:207], v254 offset:7680
    v_mfma_f32_16x16x32_bf16 v[24:27], v[192:195], a[176:179], v[24:27]
    buffer_load_dwordx4 v223, s[52:55], s50 offen offset:2048 lds
    v_mfma_f32_16x16x32_bf16 v[28:31], v[192:195], a[240:243], v[28:31]
    s_waitcnt lgkmcnt(4)
    v_mfma_f32_16x16x32_bf16 v[16:19], v[196:199], a[52:55], v[16:19]
    buffer_load_dwordx4 v223, s[52:55], s51 offen offset:3072 lds
    s_add_u32 s69, s35, 7
    s_cmp_gt_u32 s69, 7
    v_mfma_f32_16x16x32_bf16 v[20:23], v[196:199], a[116:119], v[20:23]
    s_cselect_b32 s93, 7, 0
    s_sub_u32 s69, s69, s93
    s_add_u32 s69, s69, s66
    v_mfma_f32_16x16x32_bf16 v[24:27], v[196:199], a[180:183], v[24:27]
    s_and_b32 s69, s69, 7
    s_lshl_b32 s69, s69, 7
    v_add_u32 v223, s69, v252
    v_mfma_f32_16x16x32_bf16 v[28:31], v[196:199], a[244:247], v[28:31]
    s_waitcnt lgkmcnt(0)
    s_waitcnt vmcnt(10)
    s_barrier
    v_mfma_f32_16x16x32_bf16 v[16:19], v[200:203], a[56:59], v[16:19]
    ds_read_b64_tr_b16 v[192:193], v253 offset:0
    ds_read_b64_tr_b16 v[194:195], v253 offset:512
    v_mfma_f32_16x16x32_bf16 v[20:23], v[200:203], a[120:123], v[20:23]
    ds_read_b64_tr_b16 v[196:197], v253 offset:1024
    ds_read_b64_tr_b16 v[198:199], v253 offset:1536
    v_mfma_f32_16x16x32_bf16 v[24:27], v[200:203], a[184:187], v[24:27]
    s_add_u32 m0, s89, 65536
    s_nop 0
    buffer_load_dwordx4 v223, s[52:55], 0 offen offset:0 lds
    v_mfma_f32_16x16x32_bf16 v[28:31], v[200:203], a[248:251], v[28:31]
    s_cmp_eq_u32 s100, 0
    s_cbranch_scc0 L_e13
    s_xor_b32 s70, s80, s101
    s_xor_b32 s72, s81, s101
    s_or_b32 s70, s70, s72
    s_xor_b32 s72, s82, s101
    s_or_b32 s70, s70, s72
    s_xor_b32 s72, s83, s101
    s_or_b32 s70, s70, s72
    s_cmp_eq_u32 s70, 0
    s_cbranch_scc0 L_spin1
L_back1:
    s_add_u32 s71, s34, 8192
    buffer_load_dwordx4 v[64:67], v255, s[60:63], s71 offen offset:0 sc1
    buffer_load_dwordx4 v[68:71], v255, s[60:63], s71 offen offset:1024 sc1
    s_add_u32 s71, s34, 16384
    buffer_load_dwordx4 v[72:75], v255, s[60:63], s71 offen offset:0 sc1
    buffer_load_dwordx4 v[76:79], v255, s[60:63], s71 offen offset:1024 sc1
    s_add_u32 s71, s34, 24576
    buffer_load_dwordx4 v[80:83], v255, s[60:63], s71 offen offset:0 sc1
    buffer_load_dwordx4 v[84:87], v255, s[60:63], s71 offen offset:1024 sc1
    s_lshr_b32 s72, s66, 1
    s_cmp_eq_u32 s72, s64
    s_cbranch_scc0 L_c14
    s_add_u32 s71, s78, 0
    buffer_load_dwordx4 v[120:123], v255, s[60:63], s71 offen offset:1024 sc1
    s_add_u32 s71, s78, 0
    buffer_load_dwordx4 v[124:127], v255, s[60:63], s71 offen offset:2048 sc1
    s_add_u32 s71, s78, 0
    buffer_load_dwordx4 v[128:131], v255, s[60:63], s71 offen offset:3072 sc1
L_c14:
L_e13:
    s_cmp_eq_u32 s100, 1
    s_cbranch_scc0 L_e15
    s_load_dwordx8 s[80:87], s[60:61], s33 glc
L_e15:
    v_mfma_f32_16x16x32_bf16 v[16:19], v[204:207], a[60:63], v[16:19]
    ds_read_b64_tr_b16 v[200:201], v253 offset:2048
    v_mfma_f32_16x16x32_bf16 v[20:23], v[204:207], a[124:127], v[20:23]
    ds_read_b64_tr_b16 v[202:203], v253 offset:2560
    v_mfma_f32_16x16x32_bf16 v[24:27], v[204:207], a[188:191], v[24:27]
    buffer_load_dwordx4 v223, s[52:55], s37 offen offset:1024 lds
    v_mfma_f32_16x16x32_bf16 v[28:31], v[204:207], a[252:255], v[28:31]
    s_waitcnt lgkmcnt(4)
    v_mfma_f32_16x16x32_bf16 v[0:3], v[192:195], a[0:3], 0
    ds_read_b64_tr_b16 v[204:205], v253 offset:3072
    v_mfma_f32_16x16x32_bf16 v[4:7], v[192:195], a[64:67], 0
    ds_read_b64_tr_b16 v[206:207], v253 offset:3584
    v_mfma_f32_16x16x32_bf16 v[8:11], v[192:195], a[128:131], 0
    buffer_load_dwordx4 v223, s[52:55], s38 offen offset:2048 lds
    v_mfma_f32_16x16x32_bf16 v[12:15], v[192:195], a[192:195], 0
    s_waitcnt vmcnt(11)
    s_mov_b64 exec, 1
    buffer_store_dword v149, off, s[60:63], s76 offset:16 sc1
    s_mov_b64 exec, -1
    s_waitcnt lgkmcnt(4)
    v_mfma_f32_16x16x32_bf16 v[0:3], v[196:199], a[4:7], v[0:3]
    ds_read_b64_tr_b16 v[192:193], v253 offset:4096
    v_mfma_f32_16x16x32_bf16 v[4:7], v[196:199], a[68:71], v[4:7]
    ds_read_b64_tr_b16 v[194:195], v253 offset:4608
    v_mfma_f32_16x16x32_bf16 v[8:11], v[196:199], a[132:135], v[8:11]
    buffer_load_dwordx4 v223, s[52:55], s39 offen offset:3072 lds
    v_mfma_f32_16x16x32_bf16 v[12:15], v[196:199], a[196:199], v[12:15]
    s_waitcnt lgkmcnt(4)
    v_mfma_f32_16x16x32_bf16 v[0:3], v[200:203], a[8:11], v[0:3]
    ds_read_b64_tr_b16 v[196:197], v253 offset:5120
    ds_read_b64_tr_b16 v[198:199], v253 offset:5632
    s_add_u32 m0, s89, 69632
    v_mfma_f32_16x16x32_bf16 v[4:7], v[200:203], a[72:75], v[4:7]
    buffer_load_dwordx4 v223, s[52:55], s40 offen offset:0 lds
    s_add_u32 s92, s35, 5
    s_cmp_gt_u32 s92, 7
    s_cselect_b32 s93, 7, 0
    s_sub_u32 s92, s92, s93
    s_add_u32 s92, s92, s66
    s_and_b32 s92, s92, 7
    s_lshl_b32 s77, s92, 7
    s_add_u32 s77, s77, s32
    s_mul_i32 s92, s92, 73728
    s_add_u32 s92, s92, 40960
    v_cvt_pk_bf16_f32 v40, v16, v17
    v_mfma_f32_16x16x32_bf16 v[8:11], v[200:203], a[136:139], v[8:11]
    v_cvt_pk_bf16_f32 v41, v18, v19
    v_cvt_pk_bf16_f32 v42, v20, v21
    v_cvt_pk_bf16_f32 v43, v22, v23
    v_mfma_f32_16x16x32_bf16 v[12:15], v[200:203], a[200:203], v[12:15]
    s_waitcnt lgkmcnt(4)
    v_mfma_f32_16x16x32_bf16 v[0:3], v[204:207], a[12:15], v[0:3]
    ds_read_b64_tr_b16 v[200:201], v253 offset:6144
    ds_read_b64_tr_b16 v[202:203], v253 offset:6656
    v_mfma_f32_16x16x32_bf16 v[4:7], v[204:207], a[76:79], v[4:7]
    buffer_load_dwordx4 v223, s[52:55], s41 offen offset:1024 lds
    v_cvt_pk_bf16_f32 v44, v24, v25
    v_mfma_f32_16x16x32_bf16 v[8:11], v[204:207], a[140:143], v[8:11]
    v_cvt_pk_bf16_f32 v45, v26, v27
    v_cvt_pk_bf16_f32 v46, v28, v29
    v_mfma_f32_16x16x32_bf16 v[12:15], v[204:207], a[204:207], v[12:15]
    v_cvt_pk_bf16_f32 v47, v30, v31
    s_waitcnt lgkmcnt(4)
    v_mfma_f32_16x16x32_bf16 v[0:3], v[192:195], a[16:19], v[0:3]
    ds_read_b64_tr_b16 v[204:205], v253 offset:7168
    v_mfma_f32_16x16x32_bf16 v[4:7], v[192:195], a[80:83], v[4:7]
    ds_read_b64_tr_b16 v[206:207], v253 offset:7680
    v_mfma_f32_16x16x32_bf16 v[8:11], v[192:195], a[144:147], v[8:11]
    buffer_load_dwordx4 v223, s[52:55], s42 offen offset:2048 lds
    v_mfma_f32_16x16x32_bf16 v[12:15], v[192:195], a[208:211], v[12:15]
    s_waitcnt lgkmcnt(4)
    v_mfma_f32_16x16x32_bf16 v[0:3], v[196:199], a[20:23], v[0:3]
    buffer_load_dwordx4 v223, s[52:55], s43 offen offset:3072 lds
    v_mfma_f32_16x16x32_bf16 v[4:7], v[196:199], a[84:87], v[4:7]
    buffer_store_dwordx4 v[40:43], v255, s[60:63], s92 offen offset:0 sc1
    v_mfma_f32_16x16x32_bf16 v[8:11], v[196:199], a[148:151], v[8:11]
    buffer_store_dwordx4 v[44:47], v255, s[60:63], s92 offen offset:1024 sc1
    v_mfma_f32_16x16x32_bf16 v[12:15], v[196:199], a[212:215], v[12:15]
    s_waitcnt lgkmcnt(0)
    s_waitcnt vmcnt(11)
    s_barrier
    v_mfma_f32_16x16x32_bf16 v[0:3], v[200:203], a[24:27], v[0:3]
    ds_read_b64_tr_b16 v[192:193], v253 offset:32768
    ds_read_b64_tr_b16 v[194:195], v253 offset:33280
    v_mfma_f32_16x16x32_bf16 v[4:7], v[200:203], a[88:91], v[4:7]
    ds_read_b64_tr_b16 v[196:197], v253 offset:33792
    ds_read_b64_tr_b16 v[198:199], v253 offset:34304
    v_mfma_f32_16x16x32_bf16 v[8:11], v[200:203], a[152:155], v[8:11]
    s_add_u32 m0, s89, 0
    s_nop 0
    buffer_load_dwordx4 v223, s[52:55], s44 offen offset:0 lds
    v_mfma_f32_16x16x32_bf16 v[12:15], v[200:203], a[216:219], v[12:15]
    s_cmp_eq_u32 s100, 1
    s_cbranch_scc0 L_e16
    s_xor_b32 s70, s80, s101
    s_xor_b32 s72, s81, s101
    s_or_b32 s70, s70, s72
    s_xor_b32 s72, s82, s101
    s_or_b32 s70, s70, s72
    s_xor_b32 s72, s83, s101
    s_or_b32 s70, s70, s72
    s_cmp_eq_u32 s70, 0
    s_cbranch_scc0 L_spin2
L_back2:
    s_add_u32 s71, s34, 8192
    buffer_load_dwordx4 v[64:67], v255, s[60:63], s71 offen offset:0 sc1
    buffer_load_dwordx4 v[68:71], v255, s[60:63], s71 offen offset:1024 sc1
    s_add_u32 s71, s34, 16384
    buffer_load_dwordx4 v[72:75], v255, s[60:63], s71 offen offset:0 sc1
    buffer_load_dwordx4 v[76:79], v255, s[60:63], s71 offen offset:1024 sc1
    s_add_u32 s71, s34, 24576
    buffer_load_dwordx4 v[80:83], v255, s[60:63], s71 offen offset:0 sc1
    buffer_load_dwordx4 v[84:87], v255, s[60:63], s71 offen offset:1024 sc1
    s_lshr_b32 s72, s66, 1
    s_cmp_eq_u32 s72, s64
    s_cbranch_scc0 L_c17
    s_add_u32 s71, s78, 0
    buffer_load_dwordx4 v[120:123], v255, s[60:63], s71 offen offset:1024 sc1
    s_add_u32 s71, s78, 0
    buffer_load_dwordx4 v[124:127], v255, s[60:63], s71 offen offset:2048 sc1
    s_add_u32 s71, s78, 0
    buffer_load_dwordx4 v[128:131], v255, s[60:63], s71 offen offset:3072 sc1
L_c17:
L_e16:
    s_cmp_eq_u32 s100, 2
    s_cbranch_scc0 L_e18
    s_load_dwordx8 s[80:87], s[60:61], s33 glc
L_e18:
    v_mfma_f32_16x16x32_bf16 v[0:3], v[204:207], a[28:31], v[0:3]
    ds_read_b64_tr_b16 v[200:201], v253 offset:34816
    v_mfma_f32_16x16x32_bf16 v[4:7], v[204:207], a[92:95], v[4:7]
    ds_read_b64_tr_b16 v[202:203], v253 offset:35328
    v_mfma_f32_16x16x32_bf16 v[8:11], v[204:207], a[156:159], v[8:11]
    buffer_load_dwordx4 v223, s[52:55], s45 offen offset:1024 lds
    v_mfma_f32_16x16x32_bf16 v[12:15], v[204:207], a[220:223], v[12:15]
    s_waitcnt lgkmcnt(4)
    v_mfma_f32_16x16x32_bf16 v[0:3], v[192:195], a[32:35], v[0:3]
    ds_read_b64_tr_b16 v[204:205], v253 offset:35840
    v_mfma_f32_16x16x32_bf16 v[4:7], v[192:195], a[96:99], v[4:7]
    ds_read_b64_tr_b16 v[206:207], v253 offset:36352
    v_mfma_f32_16x16x32_bf16 v[8:11], v[192:195], a[160:163], v[8:11]
    buffer_load_dwordx4 v223, s[52:55], s46 offen offset:2048 lds
    v_mfma_f32_16x16x32_bf16 v[12:15], v[192:195], a[224:227], v[12:15]
    s_waitcnt lgkmcnt(4)
    v_mfma_f32_16x16x32_bf16 v[0:3], v[196:199], a[36:39], v[0:3]
    ds_read_b64_tr_b16 v[192:193], v253 offset:36864
    v_mfma_f32_16x16x32_bf16 v[4:7], v[196:199], a[100:103], v[4:7]
    ds_read_b64_tr_b16 v[194:195], v253 offset:37376
    v_mfma_f32_16x16x32_bf16 v[8:11], v[196:199], a[164:167], v[8:11]
    buffer_load_dwordx4 v223, s[52:55], s47 offen offset:3072 lds
    v_mfma_f32_16x16x32_bf16 v[12:15], v[196:199], a[228:231], v[12:15]
    s_waitcnt lgkmcnt(4)
    v_mfma_f32_16x16x32_bf16 v[0:3], v[200:203], a[40:43], v[0:3]
    ds_read_b64_tr_b16 v[196:197], v253 offset:37888
    v_mfma_f32_16x16x32_bf16 v[4:7], v[200:203], a[104:107], v[4:7]
    ds_read_b64_tr_b16 v[198:199], v253 offset:38400
    v_mfma_f32_16x16x32_bf16 v[8:11], v[200:203], a[168:171], v[8:11]
    s_add_u32 m0, s89, 4096
    v_mfma_f32_16x16x32_bf16 v[12:15], v[200:203], a[232:235], v[12:15]
    buffer_load_dwordx4 v223, s[52:55], s48 offen offset:0 lds
    s_waitcnt lgkmcnt(4)
    v_mfma_f32_16x16x32_bf16 v[0:3], v[204:207], a[44:47], v[0:3]
    ds_read_b64_tr_b16 v[200:201], v253 offset:38912
    v_mfma_f32_16x16x32_bf16 v[4:7], v[204:207], a[108:111], v[4:7]
    ds_read_b64_tr_b16 v[202:203], v253 offset:39424
    v_mfma_f32_16x16x32_bf16 v[8:11], v[204:207], a[172:175], v[8:11]
    buffer_load_dwordx4 v223, s[52:55], s49 offen offset:1024 lds
    v_mfma_f32_16x16x32_bf16 v[12:15], v[204:207], a[236:239], v[12:15]
    s_waitcnt lgkmcnt(4)
    v_mfma_f32_16x16x32_bf16 v[0:3], v[192:195], a[48:51], v[0:3]
    ds_read_b64_tr_b16 v[204:205], v253 offset:39936
    v_mfma_f32_16x16x32_bf16 v[4:7], v[192:195], a[112:115], v[4:7]
    ds_read_b64_tr_b16 v[206:207], v253 offset:40448
    v_mfma_f32_16x16x32_bf16 v[8:11], v[192:195], a[176:179], v[8:11]
    buffer_load_dwordx4 v223, s[52:55], s50 offen offset:2048 lds
    v_mfma_f32_16x16x32_bf16 v[12:15], v[192:195], a[240:243], v[12:15]
    s_waitcnt lgkmcnt(4)
    v_mfma_f32_16x16x32_bf16 v[0:3], v[196:199], a[52:55], v[0:3]
    buffer_load_dwordx4 v223, s[52:55], s51 offen offset:3072 lds
    v_mfma_f32_16x16x32_bf16 v[4:7], v[196:199], a[116:119], v[4:7]
    s_mov_b32 s69, s66
    v_mfma_f32_16x16x32_bf16 v[8:11], v[196:199], a[180:183], v[8:11]
    s_lshl_b32 s69, s69, 7
    v_mfma_f32_16x16x32_bf16 v[12:15], v[196:199], a[244:247], v[12:15]
    v_add_u32 v223, s69, v252
    s_waitcnt lgkmcnt(0)
    s_waitcnt vmcnt(10)
    s_barrier
    v_mfma_f32_16x16x32_bf16 v[0:3], v[200:203], a[56:59], v[0:3]
    ds_read_b64_tr_b16 v[192:193], v254 offset:0
    ds_read_b64_tr_b16 v[194:195], v254 offset:512
    v_mfma_f32_16x16x32_bf16 v[4:7], v[200:203], a[120:123], v[4:7]
    ds_read_b64_tr_b16 v[196:197], v254 offset:1024
    ds_read_b64_tr_b16 v[198:199], v254 offset:1536
    v_mfma_f32_16x16x32_bf16 v[8:11], v[200:203], a[184:187], v[8:11]
    s_add_u32 m0, s89, 32768
    s_nop 0
    buffer_load_dwordx4 v223, s[52:55], 0 offen offset:0 lds
    v_mfma_f32_16x16x32_bf16 v[12:15], v[200:203], a[248:251], v[12:15]
    s_cmp_eq_u32 s100, 2
    s_cbranch_scc0 L_e19
    s_xor_b32 s70, s80, s101
    s_xor_b32 s72, s81, s101
    s_or_b32 s70, s70, s72
    s_xor_b32 s72, s82, s101
    s_or_b32 s70, s70, s72
    s_xor_b32 s72, s83, s101
    s_or_b32 s70, s70, s72
    s_cmp_eq_u32 s70, 0
    s_cbranch_scc0 L_spin3
L_back3:
    s_add_u32 s71, s34, 8192
    buffer_load_dwordx4 v[64:67], v255, s[60:63], s71 offen offset:0 sc1
    buffer_load_dwordx4 v[68:71], v255, s[60:63], s71 offen offset:1024 sc1
    s_add_u32 s71, s34, 16384
    buffer_load_dwordx4 v[72:75], v255, s[60:63], s71 offen offset:0 sc1
    buffer_load_dwordx4 v[76:79], v255, s[60:63], s71 offen offset:1024 sc1
    s_add_u32 s71, s34, 24576
    buffer_load_dwordx4 v[80:83], v255, s[60:63], s71 offen offset:0 sc1
    buffer_load_dwordx4 v[84:87], v255, s[60:63], s71 offen offset:1024 sc1
    s_lshr_b32 s72, s66, 1
    s_cmp_eq_u32 s72, s64
    s_cbranch_scc0 L_c20
    s_add_u32 s71, s78, 0
    buffer_load_dwordx4 v[120:123], v255, s[60:63], s71 offen offset:1024 sc1
    s_add_u32 s71, s78, 0
    buffer_load_dwordx4 v[124:127], v255, s[60:63], s71 offen offset:2048 sc1
    s_add_u32 s71, s78, 0
    buffer_load_dwordx4 v[128:131], v255, s[60:63], s71 offen offset:3072 sc1
L_c20:
L_e19:
    s_cmp_eq_u32 s100, 3
    s_cbranch_scc0 L_e21
    s_load_dwordx8 s[80:87], s[60:61], s33 glc
L_e21:
    v_mfma_f32_16x16x32_bf16 v[0:3], v[204:207], a[60:63], v[0:3]
    ds_read_b64_tr_b16 v[200:201], v254 offset:2048
    v_mfma_f32_16x16x32_bf16 v[4:7], v[204:207], a[124:127], v[4:7]
    ds_read_b64_tr_b16 v[202:203], v254 offset:2560
    v_mfma_f32_16x16x32_bf16 v[8:11], v[204:207], a[188:191], v[8:11]
    buffer_load_dwordx4 v223, s[52:55], s37 offen offset:1024 lds
    v_mfma_f32_16x16x32_bf16 v[12:15], v[204:207], a[252:255], v[12:15]
    s_waitcnt lgkmcnt(4)
    v_mfma_f32_16x16x32_bf16 v[16:19], v[192:195], a[0:3], 0
    ds_read_b64_tr_b16 v[204:205], v254 offset:3072
    v_mfma_f32_16x16x32_bf16 v[20:23], v[192:195], a[64:67], 0
    ds_read_b64_tr_b16 v[206:207], v254 offset:3584
    v_mfma_f32_16x16x32_bf16 v[24:27], v[192:195], a[128:131], 0
    buffer_load_dwordx4 v223, s[52:55], s38 offen offset:2048 lds
    v_mfma_f32_16x16x32_bf16 v[28:31], v[192:195], a[192:195], 0
    s_waitcnt vmcnt(11)
    s_mov_b64 exec, 1
    buffer_store_dword v149, off, s[60:63], s77 offset:20 sc1
    s_mov_b64 exec, -1
    s_waitcnt lgkmcnt(4)
    v_mfma_f32_16x16x32_bf16 v[16:19], v[196:199], a[4:7], v[16:19]
    ds_read_b64_tr_b16 v[192:193], v254 offset:4096
    v_mfma_f32_16x16x32_bf16 v[20:23], v[196:199], a[68:71], v[20:23]
    ds_read_b64_tr_b16 v[194:195], v254 offset:4608
    v_mfma_f32_16x16x32_bf16 v[24:27], v[196:199], a[132:135], v[24:27]
    buffer_load_dwordx4 v223, s[52:55], s39 offen offset:3072 lds
    v_mfma_f32_16x16x32_bf16 v[28:31], v[196:199], a[196:199], v[28:31]
    s_waitcnt lgkmcnt(4)
    v_mfma_f32_16x16x32_bf16 v[16:19], v[200:203], a[8:11], v[16:19]
    ds_read_b64_tr_b16 v[196:197], v254 offset:5120
    ds_read_b64_tr_b16 v[198:199], v254 offset:5632
    s_add_u32 m0, s89, 36864
    v_mfma_f32_16x16x32_bf16 v[20:23], v[200:203], a[72:75], v[20:23]
    buffer_load_dwordx4 v223, s[52:55], s40 offen offset:0 lds
    s_add_u32 s92, s35, 6
    s_cmp_gt_u32 s92, 7
    s_cselect_b32 s93, 7, 0
    s_sub_u32 s92, s92, s93
    s_add_u32 s92, s92, s66
    s_and_b32 s92, s92, 7
    s_lshl_b32 s76, s92, 7
    s_add_u32 s76, s76, s32
    s_mul_i32 s92, s92, 73728
    s_add_u32 s92, s92, 49152
    v_cvt_pk_bf16_f32 v32, v0, v1
    v_mfma_f32_16x16x32_bf16 v[24:27], v[200:203], a[136:139], v[24:27]
    v_cvt_pk_bf16_f32 v33, v2, v3
    v_cvt_pk_bf16_f32 v34, v4, v5
    v_cvt_pk_bf16_f32 v35, v6, v7
    v_mfma_f32_16x16x32_bf16 v[28:31], v[200:203], a[200:203], v[28:31]
    s_waitcnt lgkmcnt(4)
    v_mfma_f32_16x16x32_bf16 v[16:19], v[204:207], a[12:15], v[16:19]
    ds_read_b64_tr_b16 v[200:201], v254 offset:6144
    ds_read_b64_tr_b16 v[202:203], v254 offset:6656
    v_mfma_f32_16x16x32_bf16 v[20:23], v[204:207], a[76:79], v[20:23]
    buffer_load_dwordx4 v223, s[52:55], s41 offen offset:1024 lds
    v_cvt_pk_bf16_f32 v36, v8, v9
    v_mfma_f32_16x16x32_bf16 v[24:27], v[204:207], a[140:143], v[24:27]
    v_cvt_pk_bf16_f32 v37, v10, v11
    v_cvt_pk_bf16_f32 v38, v12, v13
    v_mfma_f32_16x16x32_bf16 v[28:31], v[204:207], a[204:207], v[28:31]
    v_cvt_pk_bf16_f32 v39, v14, v15
    s_waitcnt lgkmcnt(4)
    v_mfma_f32_16x16x32_bf16 v[16:19], v[192:195], a[16:19], v[16:19]
    ds_read_b64_tr_b16 v[204:205], v254 offset:7168
    v_mfma_f32_16x16x32_bf16 v[20:23], v[192:195], a[80:83], v[20:23]
    ds_read_b64_tr_b16 v[206:207], v254 offset:7680
    v_mfma_f32_16x16x32_bf16 v[24:27], v[192:195], a[144:147], v[24:27]
    buffer_load_dwordx4 v223, s[52:55], s42 offen offset:2048 lds
    v_mfma_f32_16x16x32_bf16 v[28:31], v[192:195], a[208:211], v[28:31]
    s_waitcnt lgkmcnt(4)
    v_mfma_f32_16x16x32_bf16 v[16:19], v[196:199], a[20:23], v[16:19]
    buffer_load_dwordx4 v223, s[52:55], s43 offen offset:3072 lds
    v_mfma_f32_16x16x32_bf16 v[20:23], v[196:199], a[84:87], v[20:23]
    buffer_store_dwordx4 v[32:35], v255, s[60:63], s92 offen offset:0 sc1
    v_mfma_f32_16x16x32_bf16 v[24:27], v[196:199], a[148:151], v[24:27]
    buffer_store_dwordx4 v[36:39], v255, s[60:63], s92 offen offset:1024 sc1
    v_mfma_f32_16x16x32_bf16 v[28:31], v[196:199], a[212:215], v[28:31]
    s_waitcnt lgkmcnt(0)
    s_waitcnt vmcnt(11)
    s_barrier
    v_mfma_f32_16x16x32_bf16 v[16:19], v[200:203], a[24:27], v[16:19]
    ds_read_b64_tr_b16 v[192:193], v253 offset:0
    ds_read_b64_tr_b16 v[194:195], v253 offset:512
    v_mfma_f32_16x16x32_bf16 v[20:23], v[200:203], a[88:91], v[20:23]
    ds_read_b64_tr_b16 v[196:197], v253 offset:1024
    ds_read_b64_tr_b16 v[198:199], v253 offset:1536
    v_mfma_f32_16x16x32_bf16 v[24:27], v[200:203], a[152:155], v[24:27]
    s_add_u32 m0, s89, 65536
    s_nop 0
    buffer_load_dwordx4 v223, s[52:55], s44 offen offset:0 lds
    v_mfma_f32_16x16x32_bf16 v[28:31], v[200:203], a[216:219], v[28:31]
    s_cmp_eq_u32 s100, 3
    s_cbranch_scc0 L_e22
    s_xor_b32 s70, s80, s101
    s_xor_b32 s72, s81, s101
    s_or_b32 s70, s70, s72
    s_xor_b32 s72, s82, s101
    s_or_b32 s70, s70, s72
    s_xor_b32 s72, s83, s101
    s_or_b32 s70, s70, s72
    s_cmp_eq_u32 s70, 0
    s_cbranch_scc0 L_spin4
L_back4:
    s_add_u32 s71, s34, 8192
    buffer_load_dwordx4 v[64:67], v255, s[60:63], s71 offen offset:0 sc1
    buffer_load_dwordx4 v[68:71], v255, s[60:63], s71 offen offset:1024 sc1
    s_add_u32 s71, s34, 16384
    buffer_load_dwordx4 v[72:75], v255, s[60:63], s71 offen offset:0 sc1
    buffer_load_dwordx4 v[76:79], v255, s[60:63], s71 offen offset:1024 sc1
    s_add_u32 s71, s34, 24576
    buffer_load_dwordx4 v[80:83], v255, s[60:63], s71 offen offset:0 sc1
    buffer_load_dwordx4 v[84:87], v255, s[60:63], s71 offen offset:1024 sc1
    s_lshr_b32 s72, s66, 1
    s_cmp_eq_u32 s72, s64
    s_cbranch_scc0 L_c23
    s_add_u32 s71, s78, 0
    buffer_load_dwordx4 v[120:123], v255, s[60:63], s71 offen offset:1024 sc1
    s_add_u32 s71, s78, 0
    buffer_load_dwordx4 v[124:127], v255, s[60:63], s71 offen offset:2048 sc1
    s_add_u32 s71, s78, 0
    buffer_load_dwordx4 v[128:131], v255, s[60:63], s71 offen offset:3072 sc1
L_c23:
L_e22:
    v_mfma_f32_16x16x32_bf16 v[16:19], v[204:207], a[28:31], v[16:19]
    ds_read_b64_tr_b16 v[200:201], v253 offset:2048
    v_mfma_f32_16x16x32_bf16 v[20:23], v[204:207], a[92:95], v[20:23]
    ds_read_b64_tr_b16 v[202:203], v253 offset:2560
    v_mfma_f32_16x16x32_bf16 v[24:27], v[204:207], a[156:159], v[24:27]
    buffer_load_dwordx4 v223, s[52:55], s45 offen offset:1024 lds
    v_mfma_f32_16x16x32_bf16 v[28:31], v[204:207], a[220:223], v[28:31]
    s_waitcnt lgkmcnt(4)
    v_mfma_f32_16x16x32_bf16 v[16:19], v[192:195], a[32:35], v[16:19]
    ds_read_b64_tr_b16 v[204:205], v253 offset:3072
    v_mfma_f32_16x16x32_bf16 v[20:23], v[192:195], a[96:99], v[20:23]
    ds_read_b64_tr_b16 v[206:207], v253 offset:3584
    v_mfma_f32_16x16x32_bf16 v[24:27], v[192:195], a[160:163], v[24:27]
    buffer_load_dwordx4 v223, s[52:55], s46 offen offset:2048 lds
    v_mfma_f32_16x16x32_bf16 v[28:31], v[192:195], a[224:227], v[28:31]
    s_waitcnt lgkmcnt(4)
    v_mfma_f32_16x16x32_bf16 v[16:19], v[196:199], a[36:39], v[16:19]
    ds_read_b64_tr_b16 v[192:193], v253 offset:4096
    v_mfma_f32_16x16x32_bf16 v[20:23], v[196:199], a[100:103], v[20:23]
    ds_read_b64_tr_b16 v[194:195], v253 offset:4608
    v_mfma_f32_16x16x32_bf16 v[24:27], v[196:199], a[164:167], v[24:27]
    buffer_load_dwordx4 v223, s[52:55], s47 offen offset:3072 lds
    v_mfma_f32_16x16x32_bf16 v[28:31], v[196:199], a[228:231], v[28:31]
    s_waitcnt lgkmcnt(4)
    v_mfma_f32_16x16x32_bf16 v[16:19], v[200:203], a[40:43], v[16:19]
    ds_read_b64_tr_b16 v[196:197], v253 offset:5120
    v_mfma_f32_16x16x32_bf16 v[20:23], v[200:203], a[104:107], v[20:23]
    ds_read_b64_tr_b16 v[198:199], v253 offset:5632
    v_mfma_f32_16x16x32_bf16 v[24:27], v[200:203], a[168:171], v[24:27]
    s_add_u32 m0, s89, 69632
    v_mfma_f32_16x16x32_bf16 v[28:31], v[200:203], a[232:235], v[28:31]
    buffer_load_dwordx4 v223, s[52:55], s48 offen offset:0 lds
    s_waitcnt lgkmcnt(4)
    v_mfma_f32_16x16x32_bf16 v[16:19], v[204:207], a[44:47], v[16:19]
    ds_read_b64_tr_b16 v[200:201], v253 offset:6144
    v_mfma_f32_16x16x32_bf16 v[20:23], v[204:207], a[108:111], v[20:23]
    ds_read_b64_tr_b16 v[202:203], v253 offset:6656
    v_mfma_f32_16x16x32_bf16 v[24:27], v[204:207], a[172:175], v[24:27]
    buffer_load_dwordx4 v223, s[52:55], s49 offen offset:1024 lds
    v_mfma_f32_16x16x32_bf16 v[28:31], v[204:207], a[236:239], v[28:31]
    s_waitcnt vmcnt(6)
    s_mov_b64 exec, 1
    buffer_store_dword v149, off, s[60:63], s76 offset:24 sc1
    s_mov_b64 exec, -1
    s_waitcnt lgkmcnt(4)
    v_mfma_f32_16x16x32_bf16 v[16:19], v[192:195], a[48:51], v[16:19]
    ds_read_b64_tr_b16 v[204:205], v253 offset:7168
    v_mfma_f32_16x16x32_bf16 v[20:23], v[192:195], a[112:115], v[20:23]
    ds_read_b64_tr_b16 v[206:207], v253 offset:7680
    v_mfma_f32_16x16x32_bf16 v[24:27], v[192:195], a[176:179], v[24:27]
    buffer_load_dwordx4 v223, s[52:55], s50 offen offset:2048 lds
    v_mfma_f32_16x16x32_bf16 v[28:31], v[192:195], a[240:243], v[28:31]
    s_waitcnt lgkmcnt(4)
    v_mfma_f32_16x16x32_bf16 v[16:19], v[196:199], a[52:55], v[16:19]
    buffer_load_dwordx4 v223, s[52:55], s51 offen offset:3072 lds
    v_mfma_f32_16x16x32_bf16 v[20:23], v[196:199], a[116:119], v[20:23]
    v_mfma_f32_16x16x32_bf16 v[24:27], v[196:199], a[180:183], v[24:27]
    v_mfma_f32_16x16x32_bf16 v[28:31], v[196:199], a[244:247], v[28:31]
    s_waitcnt lgkmcnt(0)
    s_barrier
    v_mfma_f32_16x16x32_bf16 v[16:19], v[200:203], a[56:59], v[16:19]
    s_load_dwordx8 s[80:87], s[60:61], s33 glc
    ds_read_b64_tr_b16 v[192:193], v253 offset:32768
    v_mfma_f32_16x16x32_bf16 v[20:23], v[200:203], a[120:123], v[20:23]
    ds_read_b64_tr_b16 v[194:195], v253 offset:33280
    ds_read_b64_tr_b16 v[196:197], v253 offset:33792
    v_mfma_f32_16x16x32_bf16 v[24:27], v[200:203], a[184:187], v[24:27]
    ds_read_b64_tr_b16 v[198:199], v253 offset:34304
    v_mfma_f32_16x16x32_bf16 v[28:31], v[200:203], a[248:251], v[28:31]
    v_mfma_f32_16x16x32_bf16 v[16:19], v[204:207], a[60:63], v[16:19]
    ds_read_b64_tr_b16 v[200:201], v253 offset:34816
    v_mfma_f32_16x16x32_bf16 v[20:23], v[204:207], a[124:127], v[20:23]
    ds_read_b64_tr_b16 v[202:203], v253 offset:35328
    v_mfma_f32_16x16x32_bf16 v[24:27], v[204:207], a[188:191], v[24:27]
    v_mfma_f32_16x16x32_bf16 v[28:31], v[204:207], a[252:255], v[28:31]
    s_waitcnt lgkmcnt(4)
    v_mfma_f32_16x16x32_bf16 v[0:3], v[192:195], a[0:3], 0
    ds_read_b64_tr_b16 v[204:205], v253 offset:35840
    v_mfma_f32_16x16x32_bf16 v[4:7], v[192:195], a[64:67], 0
    ds_read_b64_tr_b16 v[206:207], v253 offset:36352
    v_mfma_f32_16x16x32_bf16 v[8:11], v[192:195], a[128:131], 0
    v_mfma_f32_16x16x32_bf16 v[12:15], v[192:195], a[192:195], 0
    s_waitcnt lgkmcnt(4)
    v_mfma_f32_16x16x32_bf16 v[0:3], v[196:199], a[4:7], v[0:3]
    ds_read_b64_tr_b16 v[192:193], v253 offset:36864
    ds_read_b64_tr_b16 v[194:195], v253 offset:37376
    v_mfma_f32_16x16x32_bf16 v[4:7], v[196:199], a[68:71], v[4:7]
    s_add_u32 s92, s35, 7
    s_cmp_gt_u32 s92, 7
    s_cselect_b32 s93, 7, 0
    s_sub_u32 s92, s92, s93
    s_add_u32 s92, s92, s66
    s_and_b32 s92, s92, 7
    s_lshl_b32 s77, s92, 7
    s_add_u32 s77, s77, s32
    s_mul_i32 s92, s92, 73728
    s_add_u32 s92, s92, 57344
    v_cvt_pk_bf16_f32 v40, v16, v17
    v_mfma_f32_16x16x32_bf16 v[8:11], v[196:199], a[132:135], v[8:11]
    v_cvt_pk_bf16_f32 v41, v18, v19
    v_cvt_pk_bf16_f32 v42, v20, v21
    v_mfma_f32_16x16x32_bf16 v[12:15], v[196:199], a[196:199], v[12:15]
    v_cvt_pk_bf16_f32 v43, v22, v23
    s_waitcnt lgkmcnt(4)
    v_mfma_f32_16x16x32_bf16 v[0:3], v[200:203], a[8:11], v[0:3]
    ds_read_b64_tr_b16 v[196:197], v253 offset:37888
    ds_read_b64_tr_b16 v[198:199], v253 offset:38400
    v_mfma_f32_16x16x32_bf16 v[4:7], v[200:203], a[72:75], v[4:7]
    v_cvt_pk_bf16_f32 v44, v24, v25
    v_cvt_pk_bf16_f32 v45, v26, v27
    v_mfma_f32_16x16x32_bf16 v[8:11], v[200:203], a[136:139], v[8:11]
    v_cvt_pk_bf16_f32 v46, v28, v29
    v_cvt_pk_bf16_f32 v47, v30, v31
    v_mfma_f32_16x16x32_bf16 v[12:15], v[200:203], a[200:203], v[12:15]
    s_waitcnt lgkmcnt(4)
    v_mfma_f32_16x16x32_bf16 v[0:3], v[204:207], a[12:15], v[0:3]
    ds_read_b64_tr_b16 v[200:201], v253 offset:38912
    v_mfma_f32_16x16x32_bf16 v[4:7], v[204:207], a[76:79], v[4:7]
    ds_read_b64_tr_b16 v[202:203], v253 offset:39424
    v_mfma_f32_16x16x32_bf16 v[8:11], v[204:207], a[140:143], v[8:11]
    buffer_store_dwordx4 v[40:43], v255, s[60:63], s92 offen offset:0 sc1
    v_mfma_f32_16x16x32_bf16 v[12:15], v[204:207], a[204:207], v[12:15]
    buffer_store_dwordx4 v[44:47], v255, s[60:63], s92 offen offset:1024 sc1
    s_waitcnt lgkmcnt(4)
    v_mfma_f32_16x16x32_bf16 v[0:3], v[192:195], a[16:19], v[0:3]
    ds_read_b64_tr_b16 v[204:205], v253 offset:39936
    v_mfma_f32_16x16x32_bf16 v[4:7], v[192:195], a[80:83], v[4:7]
    ds_read_b64_tr_b16 v[206:207], v253 offset:40448
    v_mfma_f32_16x16x32_bf16 v[8:11], v[192:195], a[144:147], v[8:11]
    v_mfma_f32_16x16x32_bf16 v[12:15], v[192:195], a[208:211], v[12:15]
    s_waitcnt lgkmcnt(4)
    v_mfma_f32_16x16x32_bf16 v[0:3], v[196:199], a[20:23], v[0:3]
    v_mfma_f32_16x16x32_bf16 v[4:7], v[196:199], a[84:87], v[4:7]
    v_mfma_f32_16x16x32_bf16 v[8:11], v[196:199], a[148:151], v[8:11]
    v_mfma_f32_16x16x32_bf16 v[12:15], v[196:199], a[212:215], v[12:15]
    s_waitcnt lgkmcnt(0)
    s_waitcnt vmcnt(2)
    s_barrier
    v_mfma_f32_16x16x32_bf16 v[0:3], v[200:203], a[24:27], v[0:3]
    ds_read_b64_tr_b16 v[192:193], v254 offset:0
    v_mfma_f32_16x16x32_bf16 v[4:7], v[200:203], a[88:91], v[4:7]
    ds_read_b64_tr_b16 v[194:195], v254 offset:512
    v_mfma_f32_16x16x32_bf16 v[8:11], v[200:203], a[152:155], v[8:11]
    ds_read_b64_tr_b16 v[196:197], v254 offset:1024
    v_mfma_f32_16x16x32_bf16 v[12:15], v[200:203], a[216:219], v[12:15]
    ds_read_b64_tr_b16 v[198:199], v254 offset:1536
    s_xor_b32 s70, s84, s101
    s_xor_b32 s72, s85, s101
    s_or_b32 s70, s70, s72
    s_xor_b32 s72, s86, s101
    s_or_b32 s70, s70, s72
    s_xor_b32 s72, s87, s101
    s_or_b32 s70, s70, s72
    s_cmp_eq_u32 s70, 0
    s_cbranch_scc0 L_spin5
L_back5:
    v_mfma_f32_16x16x32_bf16 v[0:3], v[204:207], a[28:31], v[0:3]
    ds_read_b64_tr_b16 v[200:201], v254 offset:2048
    ds_read_b64_tr_b16 v[202:203], v254 offset:2560
    v_mfma_f32_16x16x32_bf16 v[4:7], v[204:207], a[92:95], v[4:7]
    s_add_u32 s71, s34, 32768
    buffer_load_dwordx4 v[88:91], v255, s[60:63], s71 offen offset:0 sc1
    v_mfma_f32_16x16x32_bf16 v[8:11], v[204:207], a[156:159], v[8:11]
    buffer_load_dwordx4 v[92:95], v255, s[60:63], s71 offen offset:1024 sc1
    v_mfma_f32_16x16x32_bf16 v[12:15], v[204:207], a[220:223], v[12:15]
    s_waitcnt lgkmcnt(4)
    v_mfma_f32_16x16x32_bf16 v[0:3], v[192:195], a[32:35], v[0:3]
    ds_read_b64_tr_b16 v[204:205], v254 offset:3072
    ds_read_b64_tr_b16 v[206:207], v254 offset:3584
    v_mfma_f32_16x16x32_bf16 v[4:7], v[192:195], a[96:99], v[4:7]
    s_add_u32 s71, s34, 40960
    buffer_load_dwordx4 v[96:99], v255, s[60:63], s71 offen offset:0 sc1
    v_mfma_f32_16x16x32_bf16 v[8:11], v[192:195], a[160:163], v[8:11]
    buffer_load_dwordx4 v[100:103], v255, s[60:63], s71 offen offset:1024 sc1
    v_mfma_f32_16x16x32_bf16 v[12:15], v[192:195], a[224:227], v[12:15]
    s_waitcnt lgkmcnt(4)
    v_mfma_f32_16x16x32_bf16 v[0:3], v[196:199], a[36:39], v[0:3]
    ds_read_b64_tr_b16 v[192:193], v254 offset:4096
    ds_read_b64_tr_b16 v[194:195], v254 offset:4608
    v_mfma_f32_16x16x32_bf16 v[4:7], v[196:199], a[100:103], v[4:7]
    s_add_u32 s71, s34, 49152
    buffer_load_dwordx4 v[104:107], v255, s[60:63], s71 offen offset:0 sc1
    v_mfma_f32_16x16x32_bf16 v[8:11], v[196:199], a[164:167], v[8:11]
    buffer_load_dwordx4 v[108:111], v255, s[60:63], s71 offen offset:1024 sc1
    v_mfma_f32_16x16x32_bf16 v[12:15], v[196:199], a[228:231], v[12:15]
    s_waitcnt lgkmcnt(4)
    v_mfma_f32_16x16x32_bf16 v[0:3], v[200:203], a[40:43], v[0:3]
    ds_read_b64_tr_b16 v[196:197], v254 offset:5120
    v_mfma_f32_16x16x32_bf16 v[4:7], v[200:203], a[104:107], v[4:7]
    ds_read_b64_tr_b16 v[198:199], v254 offset:5632
    v_mfma_f32_16x16x32_bf16 v[8:11], v[200:203], a[168:171], v[8:11]
    v_mfma_f32_16x16x32_bf16 v[12:15], v[200:203], a[232:235], v[12:15]
    s_lshr_b32 s72, s66, 1
    s_cmp_eq_u32 s72, s64
    s_cbranch_scc0 L_c24
    s_add_u32 s71, s78, 4096
    buffer_load_dwordx4 v[132:135], v255, s[60:63], s71 offen offset:0 sc1
    s_add_u32 s71, s78, 4096
    buffer_load_dwordx4 v[136:139], v255, s[60:63], s71 offen offset:1024 sc1
    s_add_u32 s71, s78, 4096
    buffer_load_dwordx4 v[140:143], v255, s[60:63], s71 offen offset:2048 sc1
    s_add_u32 s71, s78, 4096
    buffer_load_dwordx4 v[144:147], v255, s[60:63], s71 offen offset:3072 sc1
L_c24:
    s_waitcnt lgkmcnt(4)
    v_mfma_f32_16x16x32_bf16 v[0:3], v[204:207], a[44:47], v[0:3]
    ds_read_b64_tr_b16 v[200:201], v254 offset:6144
    v_mfma_f32_16x16x32_bf16 v[4:7], v[204:207], a[108:111], v[4:7]
    ds_read_b64_tr_b16 v[202:203], v254 offset:6656
    v_mfma_f32_16x16x32_bf16 v[8:11], v[204:207], a[172:175], v[8:11]
    v_mfma_f32_16x16x32_bf16 v[12:15], v[204:207], a[236:239], v[12:15]
    s_waitcnt lgkmcnt(4)
    v_mfma_f32_16x16x32_bf16 v[0:3], v[192:195], a[48:51], v[0:3]
    ds_read_b64_tr_b16 v[204:205], v254 offset:7168
    ds_read_b64_tr_b16 v[206:207], v254 offset:7680
    v_mfma_f32_16x16x32_bf16 v[4:7], v[192:195], a[112:115], v[4:7]
    s_add_u32 s71, s34, 57344
    buffer_load_dwordx4 v[112:115], v255, s[60:63], s71 offen offset:0 sc1
    v_mfma_f32_16x16x32_bf16 v[8:11], v[192:195], a[176:179], v[8:11]
    buffer_load_dwordx4 v[116:119], v255, s[60:63], s71 offen offset:1024 sc1
    v_mfma_f32_16x16x32_bf16 v[12:15], v[192:195], a[240:243], v[12:15]
    s_waitcnt lgkmcnt(4)
    v_mfma_f32_16x16x32_bf16 v[0:3], v[196:199], a[52:55], v[0:3]
    v_mfma_f32_16x16x32_bf16 v[4:7], v[196:199], a[116:119], v[4:7]
    v_mfma_f32_16x16x32_bf16 v[8:11], v[196:199], a[180:183], v[8:11]
    v_mfma_f32_16x16x32_bf16 v[12:15], v[196:199], a[244:247], v[12:15]
    s_waitcnt lgkmcnt(2)
    v_mfma_f32_16x16x32_bf16 v[0:3], v[200:203], a[56:59], v[0:3]
    v_mfma_f32_16x16x32_bf16 v[4:7], v[200:203], a[120:123], v[4:7]
    v_mfma_f32_16x16x32_bf16 v[8:11], v[200:203], a[184:187], v[8:11]
    v_mfma_f32_16x16x32_bf16 v[12:15], v[200:203], a[248:251], v[12:15]
    s_waitcnt lgkmcnt(0)
    v_mfma_f32_16x16x32_bf16 v[0:3], v[204:207], a[60:63], v[0:3]
    v_mfma_f32_16x16x32_bf16 v[4:7], v[204:207], a[124:127], v[4:7]
    v_mfma_f32_16x16x32_bf16 v[8:11], v[204:207], a[188:191], v[8:11]
    v_mfma_f32_16x16x32_bf16 v[12:15], v[204:207], a[252:255], v[12:15]
    v_mfma_f32_16x16x32_bf16 v[0:3], v[58:61], v[64:67], v[0:3]
    v_mfma_f32_16x16x32_bf16 v[8:11], v[58:61], v[68:71], v[8:11]
    v_mfma_f32_16x16x32_bf16 v[4:7], v[56:59], v[64:67], v[4:7]
    v_mfma_f32_16x16x32_bf16 v[12:15], v[56:59], v[68:71], v[12:15]
    v_mfma_f32_16x16x32_bf16 v[0:3], v[58:61], v[72:75], v[0:3]
    v_mfma_f32_16x16x32_bf16 v[8:11], v[58:61], v[76:79], v[8:11]
    v_mfma_f32_16x16x32_bf16 v[4:7], v[56:59], v[72:75], v[4:7]
    v_mfma_f32_16x16x32_bf16 v[12:15], v[56:59], v[76:79], v[12:15]
    v_mfma_f32_16x16x32_bf16 v[0:3], v[58:61], v[80:83], v[0:3]
    v_mfma_f32_16x16x32_bf16 v[8:11], v[58:61], v[84:87], v[8:11]
    v_mfma_f32_16x16x32_bf16 v[4:7], v[56:59], v[80:83], v[4:7]
    v_mfma_f32_16x16x32_bf16 v[12:15], v[56:59], v[84:87], v[12:15]
    s_waitcnt vmcnt(7)
    v_mfma_f32_16x16x32_bf16 v[0:3], v[58:61], v[88:91], v[0:3]
    s_waitcnt vmcnt(6)
    v_mfma_f32_16x16x32_bf16 v[8:11], v[58:61], v[92:95], v[8:11]
    v_mfma_f32_16x16x32_bf16 v[4:7], v[56:59], v[88:91], v[4:7]
    v_mfma_f32_16x16x32_bf16 v[12:15], v[56:59], v[92:95], v[12:15]
    s_waitcnt vmcnt(5)
    v_mfma_f32_16x16x32_bf16 v[0:3], v[58:61], v[96:99], v[0:3]
    s_waitcnt vmcnt(4)
    v_mfma_f32_16x16x32_bf16 v[8:11], v[58:61], v[100:103], v[8:11]
    v_mfma_f32_16x16x32_bf16 v[4:7], v[56:59], v[96:99], v[4:7]
    v_mfma_f32_16x16x32_bf16 v[12:15], v[56:59], v[100:103], v[12:15]
    s_waitcnt vmcnt(3)
    v_mfma_f32_16x16x32_bf16 v[0:3], v[58:61], v[104:107], v[0:3]
    s_waitcnt vmcnt(2)
    v_mfma_f32_16x16x32_bf16 v[8:11], v[58:61], v[108:111], v[8:11]
    v_mfma_f32_16x16x32_bf16 v[4:7], v[56:59], v[104:107], v[4:7]
    v_mfma_f32_16x16x32_bf16 v[12:15], v[56:59], v[108:111], v[12:15]
    s_lshr_b32 s72, s66, 1
    s_cmp_eq_u32 s72, s64
    s_cbranch_scc0 L_c25
    v_mfma_f32_16x16x32_bf16 v[48:51], v[58:61], v[120:123], v[48:51]
    v_mfma_f32_16x16x32_bf16 v[52:55], v[56:59], v[120:123], v[52:55]
    v_mfma_f32_16x16x32_bf16 v[48:51], v[58:61], v[124:127], v[48:51]
    v_mfma_f32_16x16x32_bf16 v[52:55], v[56:59], v[124:127], v[52:55]
    v_mfma_f32_16x16x32_bf16 v[48:51], v[58:61], v[128:131], v[48:51]
    v_mfma_f32_16x16x32_bf16 v[52:55], v[56:59], v[128:131], v[52:55]
    s_waitcnt vmcnt(2)
    v_mfma_f32_16x16x32_bf16 v[48:51], v[58:61], v[132:135], v[48:51]
    v_mfma_f32_16x16x32_bf16 v[52:55], v[56:59], v[132:135], v[52:55]
    v_mfma_f32_16x16x32_bf16 v[48:51], v[58:61], v[136:139], v[48:51]
    v_mfma_f32_16x16x32_bf16 v[52:55], v[56:59], v[136:139], v[52:55]
    v_mfma_f32_16x16x32_bf16 v[48:51], v[58:61], v[140:143], v[48:51]
    v_mfma_f32_16x16x32_bf16 v[52:55], v[56:59], v[140:143], v[52:55]
    v_mfma_f32_16x16x32_bf16 v[48:51], v[58:61], v[144:147], v[48:51]
    v_mfma_f32_16x16x32_bf16 v[52:55], v[56:59], v[144:147], v[52:55]
L_c25:
    s_waitcnt vmcnt(1)
    v_max3_u32 v161, v112, v113, v114
    s_waitcnt vmcnt(0)
    v_max3_u32 v162, v115, v116, v117
    v_max3_u32 v161, v161, v118, v119
    v_max_u32 v161, v161, v162
    v_cmp_eq_u32 vcc, -1, v161
    s_nop 0
    s_cmp_eq_u64 vcc, 0
    s_cbranch_scc0 L_spin6
L_back6:
    v_mfma_f32_16x16x32_bf16 v[0:3], v[58:61], v[112:115], v[0:3]
    v_mfma_f32_16x16x32_bf16 v[8:11], v[58:61], v[116:119], v[8:11]
    v_mfma_f32_16x16x32_bf16 v[4:7], v[56:59], v[112:115], v[4:7]
    v_mfma_f32_16x16x32_bf16 v[12:15], v[56:59], v[116:119], v[12:15]
    s_lshl_b32 s70, s66, 7
    s_nop 3
    v_cvt_pk_bf16_f32 v32, v0, v1
    v_cvt_pk_bf16_f32 v33, v2, v3
    v_cvt_pk_bf16_f32 v34, v4, v5
    v_cvt_pk_bf16_f32 v35, v6, v7
    v_cvt_pk_bf16_f32 v36, v8, v9
    v_cvt_pk_bf16_f32 v37, v10, v11
    v_cvt_pk_bf16_f32 v38, v12, v13
    v_cvt_pk_bf16_f32 v39, v14, v15
    v_permlane16_swap_b32 v32, v34
    v_permlane16_swap_b32 v33, v35
    v_permlane16_swap_b32 v36, v38
    v_permlane16_swap_b32 v37, v39
    buffer_store_dwordx4 v[32:35], v156, s[56:59], s70 offen
    s_add_u32 s70, s70, 73728
    buffer_store_dwordx4 v[36:39], v156, s[56:59], s70 offen
    s_lshr_b32 s72, s66, 1
    s_cmp_eq_u32 s72, s64
    s_cbranch_scc0 L_c26
    s_and_b32 s70, s66, 1
    s_mul_i32 s70, s70, 73728
    s_add_u32 s70, s70, 1024
    v_cvt_pk_bf16_f32 v40, v48, v49
    v_cvt_pk_bf16_f32 v41, v50, v51
    v_cvt_pk_bf16_f32 v42, v52, v53
    v_cvt_pk_bf16_f32 v43, v54, v55
    s_nop 0
    v_permlane16_swap_b32 v40, v42
    v_permlane16_swap_b32 v41, v43
    buffer_store_dwordx4 v[40:43], v156, s[56:59], s70 offen
L_c26:
L_end:
    s_endpgm
L_spin0:
    s_mov_b32 s93, 1000000
L_sp0:
    buffer_load_dword v220, off, s[28:31], s3 sc1
    s_waitcnt vmcnt(0)
    v_readfirstlane_b32 s101, v220
    s_nop 0
    s_cmp_lg_u32 s101, 0
    s_cbranch_scc1 L_back0
    s_sub_u32 s93, s93, 1
    s_cmp_eq_u32 s93, 0
    s_cbranch_scc0 L_sp0
    s_branch L_back0
L_spin1:
    s_mov_b32 s93, 1000000
L_sp1:
    s_load_dwordx8 s[80:87], s[60:61], s33 glc
    s_waitcnt lgkmcnt(0)
    s_xor_b32 s70, s80, s101
    s_xor_b32 s72, s81, s101
    s_or_b32 s70, s70, s72
    s_xor_b32 s72, s82, s101
    s_or_b32 s70, s70, s72
    s_xor_b32 s72, s83, s101
    s_or_b32 s70, s70, s72
    s_cmp_eq_u32 s70, 0
    s_cbranch_scc1 L_back1
    s_sub_u32 s93, s93, 1
    s_cmp_eq_u32 s93, 0
    s_cbranch_scc0 L_sp1
    s_branch L_back1
L_spin2:
    s_mov_b32 s93, 1000000
L_sp2:
    s_load_dwordx8 s[80:87], s[60:61], s33 glc
    s_waitcnt lgkmcnt(0)
    s_xor_b32 s70, s80, s101
    s_xor_b32 s72, s81, s101
    s_or_b32 s70, s70, s72
    s_xor_b32 s72, s82, s101
    s_or_b32 s70, s70, s72
    s_xor_b32 s72, s83, s101
    s_or_b32 s70, s70, s72
    s_cmp_eq_u32 s70, 0
    s_cbranch_scc1 L_back2
    s_sub_u32 s93, s93, 1
    s_cmp_eq_u32 s93, 0
    s_cbranch_scc0 L_sp2
    s_branch L_back2
L_spin3:
    s_mov_b32 s93, 1000000
L_sp3:
    s_load_dwordx8 s[80:87], s[60:61], s33 glc
    s_waitcnt lgkmcnt(0)
    s_xor_b32 s70, s80, s101
    s_xor_b32 s72, s81, s101
    s_or_b32 s70, s70, s72
    s_xor_b32 s72, s82, s101
    s_or_b32 s70, s70, s72
    s_xor_b32 s72, s83, s101
    s_or_b32 s70, s70, s72
    s_cmp_eq_u32 s70, 0
    s_cbranch_scc1 L_back3
    s_sub_u32 s93, s93, 1
    s_cmp_eq_u32 s93, 0
    s_cbranch_scc0 L_sp3
    s_branch L_back3
L_spin4:
    s_mov_b32 s93, 1000000
L_sp4:
    s_load_dwordx8 s[80:87], s[60:61], s33 glc
    s_waitcnt lgkmcnt(0)
    s_xor_b32 s70, s80, s101
    s_xor_b32 s72, s81, s101
    s_or_b32 s70, s70, s72
    s_xor_b32 s72, s82, s101
    s_or_b32 s70, s70, s72
    s_xor_b32 s72, s83, s101
    s_or_b32 s70, s70, s72
    s_cmp_eq_u32 s70, 0
    s_cbranch_scc1 L_back4
    s_sub_u32 s93, s93, 1
    s_cmp_eq_u32 s93, 0
    s_cbranch_scc0 L_sp4
    s_branch L_back4
L_spin5:
    s_mov_b32 s93, 1000000
L_sp5:
    s_load_dwordx8 s[80:87], s[60:61], s33 glc
    s_waitcnt lgkmcnt(0)
    s_xor_b32 s70, s84, s101
    s_xor_b32 s72, s85, s101
    s_or_b32 s70, s70, s72
    s_xor_b32 s72, s86, s101
    s_or_b32 s70, s70, s72
    s_xor_b32 s72, s87, s101
    s_or_b32 s70, s70, s72
    s_cmp_eq_u32 s70, 0
    s_cbranch_scc1 L_back5
    s_sub_u32 s93, s93, 1
    s_cmp_eq_u32 s93, 0
    s_cbranch_scc0 L_sp5
    s_branch L_back5
L_spin6:
    s_mov_b32 s93, 1000000
L_sp6:
    s_add_u32 s71, s34, 57344
    buffer_load_dwordx4 v[112:115], v255, s[60:63], s71 offen offset:0 sc1
    buffer_load_dwordx4 v[116:119], v255, s[60:63], s71 offen offset:1024 sc1
    s_waitcnt vmcnt(0)
    v_max3_u32 v161, v112, v113, v114
    v_max3_u32 v162, v115, v116, v117
    v_max3_u32 v161, v161, v118, v119
    v_max_u32 v161, v161, v162
    v_cmp_eq_u32 vcc, -1, v161
    s_nop 0
    s_cmp_eq_u64 vcc, 0
    s_cbranch_scc1 L_back6
    s_sub_u32 s93, s93, 1
    s_cmp_eq_u32 s93, 0
    s_cbranch_scc0 L_sp6
    s_branch L_back6
L_codeend:
.fill (49408 - (L_codeend - concat_heads__mha_block_cached__gqa_block_cached__near_ridge_kernel)) / 4, 4, 0xbf810000
.section .rodata,"a"
.p2align 6
.amdhsa_kernel concat_heads__mha_block_cached__gqa_block_cached__near_ridge_kernel
  .amdhsa_next_free_vgpr 512
  .amdhsa_next_free_sgpr 102
  .amdhsa_accum_offset 256
  .amdhsa_group_segment_fixed_size 0
  .amdhsa_kernarg_size 104
  .amdhsa_user_sgpr_count 2
  .amdhsa_user_sgpr_kernarg_segment_ptr 1
  .amdhsa_system_sgpr_workgroup_id_x 1
.end_amdhsa_kernel
```
